```python
import torch

def _softmax(x, axis=-1):
    return torch.softmax(x, dim=axis)
def _gelu(x):
    return torch.nn.functional.gelu(x, approximate="tanh")
def _silu(x):
    return torch.nn.functional.silu(x)
def _sigmoid(x):
    return torch.sigmoid(x)
def _layernorm(x, axis=-1, eps=1e-5):
    m = x.mean(dim=axis, keepdim=True)
    v = x.var(dim=axis, keepdim=True, unbiased=False)
    return (x - m) / torch.sqrt(v + eps)
def _scatter_add(tgt, idx, src, axis=0):
    return tgt.clone().index_add_(axis, idx, src)
def _segment_sum(src, seg, n):
    out = torch.zeros((n,) + src.shape[1:], dtype=src.dtype)
    return out.index_add_(0, seg, src)
def _pad(x, pw):
    flat = tuple(v for pair in reversed(pw) for v in pair)
    return torch.nn.functional.pad(x, flat)

kernel_name = 'gated_mix__sliding_block_cached__dense_activation_gelu__decode'

def setup_inputs():

    _w = (lambda a: (lambda t: t.to(torch.bfloat16) if t.is_floating_point() else t)(torch.as_tensor(a)))
    def _A_setup():
        B, Sq, D = 1, 1, 576
        Hq, Hkv, Sk, Dh = 32, 16, 32768, 128
        assert Hq % Hkv == 0, (Hq, Hkv)
        return {
            "x": _w((lambda *s: torch.randn(*s, dtype=torch.bfloat16) * 0.05)(B, Sq, D)),
            "k_cache": _w((lambda *s: torch.randn(*s, dtype=torch.bfloat16) * 3.2)(B, Hkv, Sk, Dh)),
            "v_cache": _w((lambda *s: torch.randn(*s, dtype=torch.bfloat16) * 0.2)(B, Hkv, Sk, Dh)),
            "wq": _w((lambda *s: torch.randn(*s, dtype=torch.bfloat16) * 3.2)(D, Hq * Dh) * (D ** -0.5)),
            "wo": _w((lambda *s: torch.randn(*s, dtype=torch.bfloat16) * 0.2)(Hq * Dh, D) * ((Hq * Dh) ** -0.5)),
        }
    _A_in = _A_setup()

    def _B_setup():
        B, S, D, F = 1, 1, 576, 4608
        return {
            "x": _w((lambda *s: torch.randn(*s, dtype=torch.bfloat16) * 0.05)(B, S, D)),
            "w1": _w((lambda *s: torch.randn(*s, dtype=torch.bfloat16) * 0.2)(D, F) * (D ** -0.5)),
            "b1": _w((lambda *s: torch.randn(*s, dtype=torch.bfloat16) * 0.2)(F) * 0.01),
            "w2": _w((lambda *s: torch.randn(*s, dtype=torch.bfloat16) * 0.2)(F, D) * (F ** -0.5)),
            "b2": _w((lambda *s: torch.randn(*s, dtype=torch.bfloat16) * 0.05)(D) * 0.01),
        }
    _B_in = _B_setup()

    return {
        "A_x": _A_in["x"],
        "A_k_cache": _A_in["k_cache"],
        "A_v_cache": _A_in["v_cache"],
        "A_wq": _A_in["wq"],
        "A_wo": _A_in["wo"],
        "B_x": _B_in["x"],
        "B_w1": _B_in["w1"],
        "B_b1": _B_in["b1"],
        "B_w2": _B_in["w2"],
        "B_b2": _B_in["b2"],
        "gate_w": _w((lambda *s: torch.randn(*s, dtype=torch.bfloat16) * 0.05)(576) * 16.0),
    }

def reference(A_x, A_k_cache, A_v_cache, A_wq, A_wo, B_x, B_w1, B_b1, B_w2, B_b2, gate_w):
    def _A_ref(x, k_cache, v_cache, wq, wo):
        B, Sq, D = x.shape
        Hq, Dh = 32, 128
        Hkv, Sk = k_cache.shape[1], k_cache.shape[2]
        W = min(4096, max(256, Sk // 4))
        rep = Hq // Hkv
        q = (lambda x, *d: x.permute(*d))((x @ wq).reshape(B, Sq, Hq, Dh), 0, 2, 1, 3)
        k = (lambda x, n, axis: torch.repeat_interleave(x, n, dim=axis))(k_cache[:, :, Sk - W:, :], rep, axis=1)
        v = (lambda x, n, axis: torch.repeat_interleave(x, n, dim=axis))(v_cache[:, :, Sk - W:, :], rep, axis=1)
        scores = torch.einsum("bhqd,bhkd->bhqk", q, k) * (Dh ** -0.5)
        p = _softmax(scores, axis=-1)
        o = torch.einsum("bhqk,bhkd->bhqd", p, v)
        return (lambda x, *d: x.permute(*d))(o, 0, 2, 1, 3).reshape(B, Sq, Hq * Dh) @ wo

    def _B_ref(x, w1, b1, w2, b2):
        h = torch.einsum("bsd,df->bsf", x, w1) + b1
        h = _gelu(h)
        return torch.einsum("bsf,fd->bsd", h, w2) + b2

    x = A_x
    g = _sigmoid((x * gate_w).sum(-1, keepdims=True))
    a = _A_ref(x, A_k_cache, A_v_cache, A_wq, A_wo)
    b = _B_ref(x, B_w1, B_b1, B_w2, B_b2)
    return g * a + (1 - g) * b
```

```asm
; @launch grid=(256,1,1) block=(1024,1,1) lds=14336
.amdgcn_target "amdgcn-amd-amdhsa--gfx950"
.text
.globl gated_mix__sliding_block_cached__dense_activation_gelu__decode_kernel
.p2align 8
.type gated_mix__sliding_block_cached__dense_activation_gelu__decode_kernel,@function
gated_mix__sliding_block_cached__dense_activation_gelu__decode_kernel:
    s_cmp_ge_u32 s2, 256
    s_cbranch_scc1 L_end
    s_load_dwordx16 s[8:23], s[0:1], 0
    s_load_dwordx8 s[24:31], s[0:1], 64
    s_load_dwordx4 s[32:35], s[0:1], 96
    v_readfirstlane_b32 s3, v0
    s_getpc_b64 s[56:57]
L_pc:
    s_cmp_lt_u32 s3, 960
    s_cbranch_scc1 L_nopf
    s_lshr_b32 s7, s2, 3
    s_lshl_b32 s7, s7, 2
    v_and_b32 v1, 3, v0
    v_add_lshl_u32 v1, v1, s7, 7
    v_min_u32 v1, L_end-L_pc, v1
    s_mov_b64 exec, 15
    global_load_dword v11, v1, s[56:57]
    s_mov_b64 exec, -1
L_nopf:
    v_and_b32 v0, 63, v0
    s_and_b32 s77, s2, 7
    s_lshr_b32 s78, s2, 3
    s_lshl_b32 s4, s77, 1
    s_and_b32 s7, s78, 1
    s_or_b32 s4, s4, s7
    s_lshr_b32 s5, s2, 4
    s_lshl_b32 s6, s4, 4
    s_or_b32 s6, s6, s5
    s_lshr_b32 s3, s3, 6
    s_mov_b32 s61, 0x40000
    s_mov_b32 s38, 0x20000000
    s_mov_b32 s39, 0x20000
    v_lshrrev_b32 v1, 3, v0
    v_and_b32 v2, 7, v0
    v_lshlrev_b32 v2, 4, v2
    s_cmp_ge_u32 s3, 4
    s_cbranch_scc1 L_notC
    s_setprio 3
    v_lshl_add_u32 v3, v1, 15, v2
    v_lshl_add_u32 v6, v1, 13, v2
    v_mov_b32 v9, 0x40000000
    v_cmp_gt_u32 vcc, 32, v0
    s_nop 1
    v_cndmask_b32 v6, v9, v6, vcc
    v_lshlrev_b32 v4, 1, v1
    v_lshlrev_b32 v5, 3, v1
    s_lshr_b32 s70, s5, 2
    s_mul_i32 s70, s70, 144
    s_mul_i32 s7, s3, 36
    s_add_u32 s70, s70, s7
    s_lshl_b32 s71, s70, 1
    s_lshl_b32 s72, s70, 13
    s_lshl_b32 s7, s4, 9
    s_add_u32 s72, s72, s7
    s_and_b32 s7, s5, 3
    s_lshl_b32 s7, s7, 7
    s_add_u32 s72, s72, s7
    s_add_u32 s73, s72, 0x2000
    s_add_u32 s74, s72, 0x4000
    s_add_u32 s75, s72, 0x6000
    s_add_u32 s76, s72, 0x40000
    s_mov_b32 s42, 0x480
    s_mov_b32 s43, 0x20000
    s_mov_b32 s46, 0x480000
    s_mov_b32 s47, 0x20000
    s_cmp_eq_u32 s3, 0
    s_cbranch_scc1 L_W0i
    s_mov_b32 s54, 0x510000
    s_mov_b32 s55, 0x20000
    s_and_b32 s48, s78, 3
    s_lshr_b32 s49, s78, 2
    s_sub_u32 s79, s3, 1
    v_mul_u32_u24 v62, 9216, v1
    v_lshl_add_u32 v63, v62, 3, v2
    v_add_u32 v62, v62, v2
    s_lshl_b32 s7, s79, 3
    s_lshl_b32 s51, s48, 1
    s_sub_u32 s7, s7, s51
    v_and_b32 v7, 7, v0
    v_add_u32 v7, s7, v7
    v_cmp_gt_u32 vcc, 18, v7
    s_nop 1
    v_cndmask_b32 v62, v9, v62, vcc
    v_cndmask_b32 v63, v9, v63, vcc
    v_lshlrev_b32 v7, 4, v1
    s_mul_i32 s62, s49, 663552
    s_mul_i32 s7, s77, 1152
    s_add_u32 s62, s62, s7
    s_lshl_b32 s7, s48, 1
    s_add_u32 s7, s7, s79
    s_lshl_b32 s7, s7, 7
    s_add_u32 s62, s62, s7
    s_add_u32 s63, s62, 9216
    s_add_u32 s64, s62, 18432
    s_add_u32 s65, s62, 27648
    s_add_u32 s66, s62, 36864
    s_add_u32 s67, s62, 46080
    s_add_u32 s68, s62, 55296
    s_add_u32 s69, s62, 64512
    s_add_u32 s58, s62, 589824
    s_mul_i32 s59, s49, 144
    s_waitcnt lgkmcnt(0)
    s_load_dword s60, s[34:35], 0
    s_mov_b64 s[40:41], s[8:9]
    s_mov_b64 s[44:45], s[14:15]
    buffer_load_dwordx2 v[8:9], v5, s[40:43], s71 offen
    buffer_load_ushort v10, v4, s[40:43], s71 offen offset:64
    buffer_load_dwordx4 v[16:19], v3, s[44:47], s72 offen nt
    buffer_load_dwordx4 v[20:23], v3, s[44:47], s73 offen nt
    buffer_load_dwordx4 v[24:27], v3, s[44:47], s74 offen nt
    buffer_load_dwordx4 v[28:31], v3, s[44:47], s75 offen nt
    buffer_load_dwordx4 v[32:35], v6, s[44:47], s76 offen nt
    s_mov_b64 s[52:53], s[20:21]
    buffer_load_dwordx4 v[112:115], v7, s[40:43], s59 offen
    buffer_load_ushort v116, v4, s[40:43], s59 offen offset:128
    buffer_load_dwordx4 v[64:67], v63, s[52:55], s62 offen nt
    buffer_load_dwordx4 v[68:71], v63, s[52:55], s63 offen nt
    buffer_load_dwordx4 v[72:75], v63, s[52:55], s64 offen nt
    buffer_load_dwordx4 v[76:79], v63, s[52:55], s65 offen nt
    buffer_load_dwordx4 v[80:83], v63, s[52:55], s66 offen nt
    buffer_load_dwordx4 v[84:87], v63, s[52:55], s67 offen nt
    buffer_load_dwordx4 v[88:91], v63, s[52:55], s68 offen nt
    buffer_load_dwordx4 v[92:95], v63, s[52:55], s69 offen nt
    buffer_load_dwordx4 v[96:99], v62, s[52:55], s58 offen nt
    s_barrier
    s_branch L_C
L_W0i:
    s_waitcnt lgkmcnt(0)
    s_load_dword s60, s[34:35], 0
    s_mov_b64 s[40:41], s[8:9]
    s_mov_b64 s[44:45], s[14:15]
    buffer_load_dwordx2 v[8:9], v5, s[40:43], s71 offen
    buffer_load_ushort v10, v4, s[40:43], s71 offen offset:64
    buffer_load_dwordx4 v[16:19], v3, s[44:47], s72 offen nt
    buffer_load_dwordx4 v[20:23], v3, s[44:47], s73 offen nt
    buffer_load_dwordx4 v[24:27], v3, s[44:47], s74 offen nt
    buffer_load_dwordx4 v[28:31], v3, s[44:47], s75 offen nt
    buffer_load_dwordx4 v[32:35], v6, s[44:47], s76 offen nt
    s_barrier
    s_branch L_C
L_Dstub:
    s_barrier
    s_branch L_D
L_notC:
    s_cmp_ge_u32 s3, 12
    s_cbranch_scc1 L_Dstub
    s_and_b32 s72, s3, 3
    s_lshl_b32 s73, s2, 2
    s_add_u32 s73, s73, s72
    s_mul_i32 s73, s73, 0x9e3779b1
    s_lshr_b32 s73, s73, 28
    s_mul_i32 s7, s2, 0x9e3779b1
    s_lshr_b32 s7, s7, 30
    s_xor_b32 s56, s72, s7
    s_lshl_b32 s70, s4, 23
    s_add_u32 s70, s70, 0x700000
    s_lshl_b32 s7, s5, 16
    s_add_u32 s70, s70, s7
    s_lshl_b32 s7, s56, 14
    s_add_u32 s70, s70, s7
    s_lshl_b32 s7, s73, 10
    s_or_b32 s44, s70, s7
    s_mov_b32 s42, 0x8000000
    s_mov_b32 s43, 0x20000
    v_lshlrev_b32 v5, 4, v0
    v_mov_b32 v14, 0
    s_cmp_ge_u32 s3, 8
    s_cbranch_scc1 L_V
    s_setprio 2
    v_mov_b32 v15, 0
    v_mov_b32 v12, 0
    v_mov_b32 v13, 0
    v_mov_b32 v8, 0xff800000
    v_mov_b32 v9, 0xff800000
    s_mov_b64 exec, 1
    ds_write_b128 v14, v[12:15] offset:0
    ds_write_b128 v14, v[12:15] offset:16
    ds_write_b128 v14, v[12:15] offset:48
    ds_write_b128 v14, v[12:15] offset:128
    ds_write_b128 v14, v[12:15] offset:144
    ds_write_b64 v14, v[8:9] offset:32
    s_mov_b64 exec, -1
    v_bfe_u32 v4, v0, 3, 1
    s_and_b32 s7, s73, 1
    v_xor_b32 v4, s7, v4
    v_lshl_add_u32 v4, v4, 10, v2
    v_lshrrev_b32 v3, 4, v0
    v_lshl_add_u32 v4, v3, 8, v4
    s_and_b32 s44, s44, 0xfffff800
    s_xor_b32 s45, s44, 0x800
    s_xor_b32 s46, s44, 0x1000
    s_xor_b32 s47, s44, 0x1800
    s_xor_b32 s48, s44, 0x2000
    s_xor_b32 s49, s44, 0x2800
    s_xor_b32 s50, s44, 0x3000
    s_xor_b32 s51, s44, 0x3800
    s_waitcnt lgkmcnt(0)
    s_mov_b64 s[40:41], s[10:11]
    v_mov_b32 v15, 1
    s_barrier
    buffer_load_dwordx4 v[16:19], v4, s[40:43], s44 offen offset:0 nt
    buffer_load_dwordx4 v[20:23], v4, s[40:43], s44 offen offset:128 nt
    buffer_load_dwordx4 v[24:27], v4, s[40:43], s45 offen offset:0 nt
    buffer_load_dwordx4 v[28:31], v4, s[40:43], s45 offen offset:128 nt
L_lw_1:
    ds_read_b32 v10, v14 offset:56
    s_waitcnt lgkmcnt(0)
    v_readfirstlane_b32 s7, v10
    s_cmp_ge_u32 s7, 1
    s_cbranch_scc1 L_lwd_2
    s_sub_u32 s61, s61, 1
    s_cbranch_scc0 L_lw_1
    s_endpgm
L_lwd_2:
    buffer_load_dwordx4 v[32:35], v4, s[40:43], s46 offen offset:0 nt
    buffer_load_dwordx4 v[36:39], v4, s[40:43], s46 offen offset:128 nt
    buffer_load_dwordx4 v[40:43], v4, s[40:43], s47 offen offset:0 nt
    buffer_load_dwordx4 v[44:47], v4, s[40:43], s47 offen offset:128 nt
    s_nop 0
    buffer_load_dwordx4 v[48:51], v4, s[40:43], s48 offen offset:0 nt
    buffer_load_dwordx4 v[52:55], v4, s[40:43], s48 offen offset:128 nt
    buffer_load_dwordx4 v[56:59], v4, s[40:43], s49 offen offset:0 nt
    buffer_load_dwordx4 v[60:63], v4, s[40:43], s49 offen offset:128 nt
    s_nop 0
    buffer_load_dwordx4 v[64:67], v4, s[40:43], s50 offen offset:0 nt
    buffer_load_dwordx4 v[68:71], v4, s[40:43], s50 offen offset:128 nt
    buffer_load_dwordx4 v[72:75], v4, s[40:43], s51 offen offset:0 nt
    buffer_load_dwordx4 v[76:79], v4, s[40:43], s51 offen offset:128 nt
    s_mov_b64 exec, 1
    ds_add_u32 v14, v15 offset:20
    s_mov_b64 exec, -1
    s_branch L_K
L_V:
    s_cmp_le_u32 s2, 0
    s_cselect_b32 s7, s3, 0
    s_cmp_eq_u32 s7, 8
    s_cbranch_scc1 L_init
    s_barrier
    s_branch L_V2
L_C:
    s_mov_b64 s[36:37], s[34:35]
    s_getreg_b32 s0, hwreg(HW_REG_XCC_ID)
    s_and_b32 s0, s0, 15
    s_add_u32 s0, s0, 1
    s_mul_i32 s0, s0, 0x01000193
    s_mov_b32 s62, 0x3030303
    s_mov_b32 s63, 0x3030303
    s_mov_b32 s64, 0xc0c0c0c
    s_mov_b32 s65, 0xc0c0c0c
    s_mov_b32 s66, 0x30303030
    s_mov_b32 s67, 0x30303030
    s_mov_b32 s68, 0xc0c0c0c0
    s_mov_b32 s69, 0xc0c0c0c0
    v_and_b32 v5, 1, v0
    v_cmp_eq_u32 vcc, 1, v5
    v_mov_b32 v11, 0x0c0c0100
    v_mov_b32 v5, 0x01000c0c
    v_cndmask_b32 v11, v11, v5, vcc
    v_mov_b32 v12, 0x0c0c0302
    v_mov_b32 v5, 0x03020c0c
    v_cndmask_b32 v12, v12, v5, vcc
    v_and_b32 v62, 7, v0
    v_lshlrev_b32 v62, 2, v62
    v_bfe_u32 v63, v0, 4, 1
    v_lshl_add_u32 v62, v63, 1, v62
    v_lshrrev_b32 v61, 5, v0
    v_add_u32 v62, v62, v61
    v_mov_b32 v100, 0
    v_mov_b32 v101, 1
    s_lshl_b32 s7, s3, 8
    v_lshl_add_u32 v63, v62, 3, s7
    s_cmp_eq_u32 s3, 0
    s_cbranch_scc1 L_rw_7
    s_waitcnt vmcnt(16)
    s_branch L_rwd_8
L_rw_7:
    s_waitcnt vmcnt(5)
L_rwd_8:
    v_perm_b32 v36, v8, v8, v11
    v_cndmask_b32 v40, 0, v36, s[62:63]
    v_cndmask_b32 v41, 0, v36, s[64:65]
    v_cndmask_b32 v42, 0, v36, s[66:67]
    v_cndmask_b32 v43, 0, v36, s[68:69]
    v_perm_b32 v37, v8, v8, v12
    v_cndmask_b32 v44, 0, v37, s[62:63]
    v_cndmask_b32 v45, 0, v37, s[64:65]
    v_cndmask_b32 v46, 0, v37, s[66:67]
    v_cndmask_b32 v47, 0, v37, s[68:69]
    v_perm_b32 v36, v9, v9, v11
    v_cndmask_b32 v48, 0, v36, s[62:63]
    v_cndmask_b32 v49, 0, v36, s[64:65]
    v_cndmask_b32 v50, 0, v36, s[66:67]
    v_cndmask_b32 v51, 0, v36, s[68:69]
    v_perm_b32 v37, v9, v9, v12
    v_cndmask_b32 v52, 0, v37, s[62:63]
    v_cndmask_b32 v53, 0, v37, s[64:65]
    v_cndmask_b32 v54, 0, v37, s[66:67]
    v_cndmask_b32 v55, 0, v37, s[68:69]
    v_perm_b32 v36, v10, v10, v11
    v_cndmask_b32 v56, 0, v36, s[62:63]
    v_cndmask_b32 v57, 0, v36, s[64:65]
    v_cndmask_b32 v58, 0, v36, s[66:67]
    v_cndmask_b32 v59, 0, v36, s[68:69]
    s_waitcnt lgkmcnt(0)
    s_mul_i32 s60, s60, 1664525
    s_add_u32 s60, s60, 1013904223
    s_xor_b32 s81, s60, s0
    s_cmp_eq_u32 s3, 0
    s_cbranch_scc1 L_rw_9
    s_waitcnt vmcnt(11)
    s_branch L_rwd_10
L_rw_9:
    s_waitcnt vmcnt(0)
L_rwd_10:
    s_nop 1
    v_mfma_f32_16x16x32_bf16 v[36:39], v[40:43], v[16:19], 0
    v_mfma_f32_16x16x32_bf16 v[36:39], v[44:47], v[20:23], v[36:39]
    v_mfma_f32_16x16x32_bf16 v[36:39], v[48:51], v[24:27], v[36:39]
    v_mfma_f32_16x16x32_bf16 v[36:39], v[52:55], v[28:31], v[36:39]
    v_mfma_f32_16x16x32_bf16 v[36:39], v[56:59], v[32:35], v[36:39]
    s_nop 7
    v_permlane32_swap_b32 v36, v38
    v_permlane32_swap_b32 v37, v39
    s_nop 0
    v_add_f32_dpp v40, v38, v36 row_ror:8 row_mask:0xf bank_mask:0xf
    v_add_f32_dpp v41, v39, v37 row_ror:8 row_mask:0xf bank_mask:0xf
    s_mov_b32 exec_lo, 0xff00ff
    s_mov_b32 exec_hi, 0xff00ff
    ds_write_b64 v63, v[40:41] offset:1024
    s_mov_b64 exec, 1
    ds_add_u32 v100, v101 offset:0
    s_mov_b64 exec, -1
    s_cmp_lg_u32 s3, 0
    s_cbranch_scc1 L_C2
    v_and_b32 v44, 31, v0
    v_lshlrev_b32 v45, 3, v44
    v_lshlrev_b32 v44, 4, v44
    v_lshlrev_b32 v60, 4, v0
    v_mov_b32 v117, s81
    v_mov_b32 v119, s81
    s_mul_i32 s72, s6, 640
    s_add_u32 s72, s72, 0x2000
L_lw_23:
    ds_read_b32 v20, v100 offset:0
    s_waitcnt lgkmcnt(0)
    v_readfirstlane_b32 s7, v20
    s_cmp_ge_u32 s7, 4
    s_cbranch_scc1 L_lwd_24
    s_sub_u32 s61, s61, 1
    s_cbranch_scc0 L_lw_23
    s_endpgm
L_lwd_24:
    ds_read_b64 v[48:49], v45 offset:1024
    ds_read_b64 v[50:51], v45 offset:1280
    ds_read_b64 v[52:53], v45 offset:1536
    ds_read_b64 v[54:55], v45 offset:1792
    s_waitcnt lgkmcnt(0)
    v_add_f32 v48, v48, v50
    v_add_f32 v49, v49, v51
    v_add_f32 v52, v52, v54
    v_add_f32 v53, v53, v55
    v_add_f32 v116, v48, v52
    v_add_f32 v118, v49, v53
    s_mov_b32 exec_hi, 0
    buffer_store_dwordx4 v[116:119], v44, s[36:39], s72 offen
    s_mov_b32 exec_hi, -1
    s_mov_b64 exec, 1
    ds_add_u32 v100, v101 offset:56
    s_mov_b64 exec, -1
    s_branch L_W0b
L_C2:
    s_waitcnt vmcnt(9)
    v_perm_b32 v13, v112, v112, v11
    v_cndmask_b32 v16, 0, v13, s[62:63]
    v_cndmask_b32 v17, 0, v13, s[64:65]
    v_cndmask_b32 v18, 0, v13, s[66:67]
    v_cndmask_b32 v19, 0, v13, s[68:69]
    v_perm_b32 v14, v112, v112, v12
    v_cndmask_b32 v20, 0, v14, s[62:63]
    v_cndmask_b32 v21, 0, v14, s[64:65]
    v_cndmask_b32 v22, 0, v14, s[66:67]
    v_cndmask_b32 v23, 0, v14, s[68:69]
    v_perm_b32 v13, v113, v113, v11
    v_cndmask_b32 v24, 0, v13, s[62:63]
    v_cndmask_b32 v25, 0, v13, s[64:65]
    v_cndmask_b32 v26, 0, v13, s[66:67]
    v_cndmask_b32 v27, 0, v13, s[68:69]
    v_perm_b32 v14, v113, v113, v12
    v_cndmask_b32 v28, 0, v14, s[62:63]
    v_cndmask_b32 v29, 0, v14, s[64:65]
    v_cndmask_b32 v30, 0, v14, s[66:67]
    v_cndmask_b32 v31, 0, v14, s[68:69]
    v_perm_b32 v13, v114, v114, v11
    v_cndmask_b32 v32, 0, v13, s[62:63]
    v_cndmask_b32 v33, 0, v13, s[64:65]
    v_cndmask_b32 v34, 0, v13, s[66:67]
    v_cndmask_b32 v35, 0, v13, s[68:69]
    v_perm_b32 v14, v114, v114, v12
    v_cndmask_b32 v36, 0, v14, s[62:63]
    v_cndmask_b32 v37, 0, v14, s[64:65]
    v_cndmask_b32 v38, 0, v14, s[66:67]
    v_cndmask_b32 v39, 0, v14, s[68:69]
    v_perm_b32 v13, v115, v115, v11
    v_cndmask_b32 v40, 0, v13, s[62:63]
    v_cndmask_b32 v41, 0, v13, s[64:65]
    v_cndmask_b32 v42, 0, v13, s[66:67]
    v_cndmask_b32 v43, 0, v13, s[68:69]
    v_perm_b32 v14, v115, v115, v12
    v_cndmask_b32 v44, 0, v14, s[62:63]
    v_cndmask_b32 v45, 0, v14, s[64:65]
    v_cndmask_b32 v46, 0, v14, s[66:67]
    v_cndmask_b32 v47, 0, v14, s[68:69]
    v_perm_b32 v13, v116, v116, v11
    v_cndmask_b32 v48, 0, v13, s[62:63]
    v_cndmask_b32 v49, 0, v13, s[64:65]
    v_cndmask_b32 v50, 0, v13, s[66:67]
    v_cndmask_b32 v51, 0, v13, s[68:69]
    v_mov_b32 v105, s81
    v_mov_b32 v107, s81
    v_lshrrev_b32 v63, 4, v0
    v_mul_u32_u24 v63, 384, v63
    v_add_u32 v63, v63, v2
    s_lshl_b32 s70, s77, 2
    s_add_u32 s70, s70, s48
    s_mul_i32 s70, s70, 13312
    s_add_u32 s70, s70, 0x100000
    s_mul_i32 s71, s49, 1664
    s_add_u32 s71, s71, s70
    s_lshl_b32 s7, s79, 7
    s_add_u32 s71, s71, s7
    s_waitcnt vmcnt(8)
    v_mfma_f32_16x16x32_bf16 v[56:59], v[16:19], v[64:67], 0
    s_waitcnt vmcnt(7)
    v_mfma_f32_16x16x32_bf16 v[56:59], v[20:23], v[68:71], v[56:59]
    s_waitcnt vmcnt(6)
    v_mfma_f32_16x16x32_bf16 v[56:59], v[24:27], v[72:75], v[56:59]
    s_waitcnt vmcnt(5)
    v_mfma_f32_16x16x32_bf16 v[56:59], v[28:31], v[76:79], v[56:59]
    s_waitcnt vmcnt(4)
    v_mfma_f32_16x16x32_bf16 v[56:59], v[32:35], v[80:83], v[56:59]
    s_waitcnt vmcnt(3)
    v_mfma_f32_16x16x32_bf16 v[56:59], v[36:39], v[84:87], v[56:59]
    s_waitcnt vmcnt(2)
    v_mfma_f32_16x16x32_bf16 v[56:59], v[40:43], v[88:91], v[56:59]
    s_waitcnt vmcnt(1)
    v_mfma_f32_16x16x32_bf16 v[56:59], v[44:47], v[92:95], v[56:59]
    s_waitcnt vmcnt(0)
    v_mfma_f32_16x16x32_bf16 v[56:59], v[48:51], v[96:99], v[56:59]
    s_nop 7
    v_permlane32_swap_b32 v56, v58
    v_permlane32_swap_b32 v57, v59
    s_nop 0
    v_add_f32_dpp v104, v58, v56 row_ror:8 row_mask:0xf bank_mask:0xf
    v_add_f32_dpp v106, v59, v57 row_ror:8 row_mask:0xf bank_mask:0xf
    s_mov_b32 exec_lo, 0xff00ff
    s_mov_b32 exec_hi, 0xff00ff
    buffer_store_dwordx4 v[104:107], v63, s[36:39], s71 offen
    s_mov_b64 exec, -1
    s_mov_b32 s57, 0
    s_and_b32 s72, s5, 3
    s_and_b32 s5, s5, 12
    s_add_u32 s5, s5, s79
    s_lshl_b32 s6, s4, 4
    s_or_b32 s6, s6, s5
    s_and_b32 s7, s4, 1
    s_lshl_b32 s78, s5, 1
    s_or_b32 s78, s78, s7
    s_max_u32 s7, s72, s3
    s_cmp_eq_u32 s7, 3
    s_cbranch_scc1 L_Hend
    s_and_b32 s74, s78, 3
    s_bfe_u32 s75, s78, 0x10002
    s_mul_i32 s75, s75, 9
    s_lshl_b32 s7, s74, 1
    s_add_u32 s75, s75, s7
    s_mul_i32 s73, s77, 576
    s_lshl_b32 s7, s74, 7
    s_add_u32 s73, s73, s7
    s_lshl_b32 s7, s75, 3
    s_add_u32 s73, s73, s7
    s_bfe_u32 s7, s78, 0x10003
    s_lshl_b32 s7, s7, 2
    s_add_u32 s73, s73, s7
    s_bfe_u32 s7, s78, 0x10004
    s_lshl_b32 s7, s7, 1
    s_add_u32 s73, s73, s7
    s_lshr_b32 s76, s78, 3
    s_mul_i32 s76, s76, 384
    s_lshl_b32 s7, s75, 4
    s_add_u32 s76, s76, s7
    s_lshl_b32 s70, s77, 2
    s_add_u32 s70, s70, s74
    s_mul_i32 s70, s70, 13312
    s_add_u32 s70, s70, 0x100000
    s_mov_b32 s50, 0x2400
    s_mov_b32 s51, 0x20000
    s_mov_b64 s[48:49], s[22:23]
    v_and_b32 v6, 31, v0
    v_min_u32 v6, 17, v6
    v_lshl_add_u32 v60, v6, 3, v61
    v_lshlrev_b32 v60, 1, v60
    s_lshl_b32 s72, s73, 1
    v_mul_u32_u24 v44, 1664, v61
    v_lshl_add_u32 v44, v6, 4, v44
    s_add_u32 s8, s70, s76
    s_add_u32 s9, s8, 6656
    v_lshl_add_u32 v45, v6, 1, v61
    s_lshl_b32 s7, s79, 7
    v_lshl_add_u32 v45, v45, 1, s7
    s_waitcnt vmcnt(0)
    buffer_load_dwordx4 v[64:67], v44, s[36:39], s8 offen offset:0 sc1
    buffer_load_dwordx4 v[68:71], v44, s[36:39], s8 offen offset:3328 sc1
    buffer_load_dwordx4 v[72:75], v44, s[36:39], s9 offen offset:0 sc1
    buffer_load_dwordx4 v[76:79], v44, s[36:39], s9 offen offset:3328 sc1
    buffer_load_ushort v46, v60, s[48:51], s72 offen
    s_mov_b32 s80, 0
    s_mov_b32 s1, s81
    s_mov_b64 s[12:13], -1
    s_mov_b64 s[14:15], -1
    s_mov_b64 s[16:17], -1
    s_mov_b64 s[18:19], -1
    s_waitcnt vmcnt(0)
    s_branch L_gc_13
L_gp_11:
    s_add_u32 s80, s80, 1
    s_cmp_lt_u32 s80, 2
    s_cbranch_scc1 L_gf_14
    v_xor_b32 v44, 0x400000, v44
    s_xor_b32 s1, s1, s0
L_gf_14:
    s_mov_b64 exec, s[12:13]
    s_cbranch_execz L_gs_15
    buffer_load_dwordx4 v[64:67], v44, s[36:39], s8 offen offset:0 sc1
L_gs_15:
    s_mov_b64 exec, s[14:15]
    s_cbranch_execz L_gs_16
    buffer_load_dwordx4 v[68:71], v44, s[36:39], s8 offen offset:3328 sc1
L_gs_16:
    s_mov_b64 exec, s[16:17]
    s_cbranch_execz L_gs_17
    buffer_load_dwordx4 v[72:75], v44, s[36:39], s9 offen offset:0 sc1
L_gs_17:
    s_mov_b64 exec, s[18:19]
    s_cbranch_execz L_gs_18
    buffer_load_dwordx4 v[76:79], v44, s[36:39], s9 offen offset:3328 sc1
L_gs_18:
    s_mov_b64 exec, -1
    s_waitcnt vmcnt(0)
L_gc_13:
    v_cmp_ne_u32 s[74:75], s1, v65
    v_cmp_ne_u32 vcc, s1, v67
    s_or_b64 vcc, s[74:75], vcc
    s_and_b64 s[12:13], s[12:13], vcc
    v_cmp_ne_u32 s[74:75], s1, v69
    v_cmp_ne_u32 vcc, s1, v71
    s_or_b64 vcc, s[74:75], vcc
    s_and_b64 s[14:15], s[14:15], vcc
    s_or_b64 s[82:83], s[12:13], s[14:15]
    v_cmp_ne_u32 s[74:75], s1, v73
    v_cmp_ne_u32 vcc, s1, v75
    s_or_b64 vcc, s[74:75], vcc
    s_and_b64 s[16:17], s[16:17], vcc
    s_or_b64 s[82:83], s[82:83], s[16:17]
    v_cmp_ne_u32 s[74:75], s1, v77
    v_cmp_ne_u32 vcc, s1, v79
    s_or_b64 vcc, s[74:75], vcc
    s_and_b64 s[18:19], s[18:19], vcc
    s_or_b64 s[82:83], s[82:83], s[18:19]
    s_cbranch_scc0 L_gpd_12
    ds_read_b32 v20, v100 offset:28
    s_waitcnt lgkmcnt(0)
    v_readfirstlane_b32 s7, v20
    s_cmp_le_u32 s7, s57
    s_cbranch_scc1 L_fc_19
    s_mov_b32 s57, 1
    v_mov_b32 v105, s60
    v_mov_b32 v107, s60
    s_add_u32 s71, s71, 0x400000
    s_mov_b32 exec_lo, 0xff00ff
    s_mov_b32 exec_hi, 0xff00ff
    buffer_store_dwordx4 v[104:107], v63, s[36:39], s71 offen sc1
    s_mov_b64 exec, -1
L_fc_19:
    s_sleep 1
    s_sub_u32 s61, s61, 1
    s_cbranch_scc0 L_gp_11
    s_endpgm
L_gpd_12:
    v_add_f32 v64, v64, v68
    v_add_f32 v66, v66, v70
    v_add_f32 v72, v72, v76
    v_add_f32 v74, v74, v78
    v_add_f32 v64, v64, v72
    v_add_f32 v66, v66, v74
    v_lshlrev_b32 v46, 16, v46
    s_nop 0
    v_permlane32_swap_b32 v64, v66
    v_add_f32 v16, v64, v66
    v_cvt_pk_bf16_f32 v16, v16, v16
    v_and_b32 v16, 0xffff0000, v16
    v_add_f32 v16, v16, v46
    v_cvt_pk_bf16_f32 v16, v16, v16
    v_and_b32 v16, 0xffff0000, v16
    v_mul_f32 v17, v16, v16
    v_mov_b32 v18, 0xc0135761
    v_mul_f32 v19, 0xbdd2d3e8, v17
    v_add_f32 v19, v19, v18
    v_mul_f32 v19, v19, v16
    v_exp_f32 v19, v19
    s_nop 0
    v_add_f32 v19, 1.0, v19
    v_rcp_f32 v19, v19
    s_nop 0
    v_mul_f32 v16, v16, v19
    v_cvt_pk_bf16_f32 v16, v16, v16
    ds_write_b16 v45, v16 offset:2048
    s_mov_b64 exec, 1
    ds_add_u32 v100, v101 offset:16
    s_mov_b64 exec, -1
L_Hend:
L_hw_20:
    ds_read_b32 v21, v100 offset:4
    ds_read_b32 v20, v100 offset:28
    s_waitcnt lgkmcnt(0)
    v_readfirstlane_b32 s7, v20
    s_cmp_le_u32 s7, s57
    s_cbranch_scc1 L_fc_22
    s_mov_b32 s57, 1
    v_mov_b32 v105, s60
    v_mov_b32 v107, s60
    s_add_u32 s71, s71, 0x400000
    s_mov_b32 exec_lo, 0xff00ff
    s_mov_b32 exec_hi, 0xff00ff
    buffer_store_dwordx4 v[104:107], v63, s[36:39], s71 offen sc1
    s_mov_b64 exec, -1
L_fc_22:
    v_readfirstlane_b32 s7, v21
    s_cmp_lg_u32 s7, 0
    s_cbranch_scc1 L_hwd_21
    s_sleep 4
    s_sub_u32 s61, s61, 1
    s_cbranch_scc0 L_hw_20
    s_endpgm
L_hwd_21:
    s_endpgm
L_V2:
    s_setprio 1
    s_xor_b32 s45, s44, 0x400
    s_xor_b32 s46, s44, 0x800
    s_xor_b32 s47, s44, 0xc00
    s_xor_b32 s48, s44, 0x1000
    s_xor_b32 s49, s44, 0x1400
    s_xor_b32 s50, s44, 0x1800
    s_xor_b32 s51, s44, 0x1c00
    s_xor_b32 s52, s44, 0x2000
    s_xor_b32 s53, s44, 0x2400
    s_xor_b32 s54, s44, 0x2800
    s_xor_b32 s55, s44, 0x2c00
    s_xor_b32 s56, s44, 0x3000
    s_xor_b32 s57, s44, 0x3400
    s_xor_b32 s58, s44, 0x3800
    s_xor_b32 s59, s44, 0x3c00
    v_mov_b32 v15, 1
    v_and_b32 v4, 15, v0
    v_lshlrev_b32 v4, 6, v4
    v_bfe_u32 v6, v0, 4, 1
    v_lshl_add_u32 v4, v6, 5, v4
    v_lshrrev_b32 v6, 5, v0
    v_lshl_add_u32 v4, v6, 3, v4
    s_lshl_b32 s7, s72, 10
    s_add_u32 s7, s7, 0x1000
    v_add_u32 v4, s7, v4
    s_lshl_b32 s7, s72, 9
    v_lshl_add_u32 v3, v0, 3, s7
    s_mov_b32 s62, 0x3030303
    s_mov_b32 s63, 0x3030303
    s_mov_b32 s64, 0xc0c0c0c
    s_mov_b32 s65, 0xc0c0c0c
    s_mov_b32 s66, 0x30303030
    s_mov_b32 s67, 0x30303030
    s_mov_b32 s68, 0xc0c0c0c0
    s_mov_b32 s69, 0xc0c0c0c0
    v_and_b32 v10, 1, v0
    v_cmp_eq_u32 vcc, 1, v10
    v_mov_b32 v11, 0xffff
    v_mov_b32 v10, 0xffff0000
    v_cndmask_b32 v11, v11, v10, vcc
    s_lshl_b32 s7, s72, 2
    v_mov_b32 v6, s7
L_lw_3:
    ds_read_b32 v10, v14 offset:20
    s_waitcnt lgkmcnt(0)
    v_readfirstlane_b32 s7, v10
    s_cmp_ge_u32 s7, 4
    s_cbranch_scc1 L_lwd_4
    s_sleep 1
    s_sub_u32 s61, s61, 1
    s_cbranch_scc0 L_lw_3
    s_endpgm
L_lwd_4:
    s_mov_b64 s[40:41], s[12:13]
    buffer_load_dwordx4 v[16:19], v5, s[40:43], s44 offen nt
    buffer_load_dwordx4 v[20:23], v5, s[40:43], s45 offen nt
    buffer_load_dwordx4 v[24:27], v5, s[40:43], s46 offen nt
    buffer_load_dwordx4 v[28:31], v5, s[40:43], s47 offen nt
    s_nop 0
    buffer_load_dwordx4 v[32:35], v5, s[40:43], s48 offen nt
    buffer_load_dwordx4 v[36:39], v5, s[40:43], s49 offen nt
    buffer_load_dwordx4 v[40:43], v5, s[40:43], s50 offen nt
    buffer_load_dwordx4 v[44:47], v5, s[40:43], s51 offen nt
    s_nop 0
    buffer_load_dwordx4 v[48:51], v5, s[40:43], s52 offen nt
    buffer_load_dwordx4 v[52:55], v5, s[40:43], s53 offen nt
    buffer_load_dwordx4 v[56:59], v5, s[40:43], s54 offen nt
    buffer_load_dwordx4 v[60:63], v5, s[40:43], s55 offen nt
    s_nop 0
    buffer_load_dwordx4 v[64:67], v5, s[40:43], s56 offen nt
    buffer_load_dwordx4 v[68:71], v5, s[40:43], s57 offen nt
    buffer_load_dwordx4 v[72:75], v5, s[40:43], s58 offen nt
    buffer_load_dwordx4 v[76:79], v5, s[40:43], s59 offen nt
    s_mov_b64 exec, 1
    ds_add_u32 v14, v15 offset:24
    s_mov_b64 exec, -1
L_pw_5:
    ds_read_b32 v10, v6 offset:128
    ds_read_b64 v[8:9], v3 offset:8192
    s_waitcnt lgkmcnt(0)
    v_readfirstlane_b32 s7, v10
    s_cmp_lg_u32 s7, 0
    s_cbranch_scc1 L_pwd_6
    s_sleep 1
    s_sub_u32 s61, s61, 1
    s_cbranch_scc0 L_pw_5
    s_endpgm
L_pwd_6:
    v_and_b32_dpp v12, v8, v11 row_newbcast:0 row_mask:0xf bank_mask:0x3
    s_nop 1
    v_and_b32_dpp v12, v8, v11 row_newbcast:1 row_mask:0xf bank_mask:0xc
    v_cndmask_b32 v80, 0, v12, s[62:63]
    v_cndmask_b32 v81, 0, v12, s[64:65]
    v_cndmask_b32 v82, 0, v12, s[66:67]
    v_cndmask_b32 v83, 0, v12, s[68:69]
    v_and_b32_dpp v13, v8, v11 row_newbcast:8 row_mask:0xf bank_mask:0x3
    s_nop 1
    v_and_b32_dpp v13, v8, v11 row_newbcast:9 row_mask:0xf bank_mask:0xc
    v_cndmask_b32 v84, 0, v13, s[62:63]
    v_cndmask_b32 v85, 0, v13, s[64:65]
    v_cndmask_b32 v86, 0, v13, s[66:67]
    v_cndmask_b32 v87, 0, v13, s[68:69]
    v_and_b32_dpp v12, v8, v11 row_newbcast:2 row_mask:0xf bank_mask:0x3
    s_nop 1
    v_and_b32_dpp v12, v8, v11 row_newbcast:3 row_mask:0xf bank_mask:0xc
    v_cndmask_b32 v88, 0, v12, s[62:63]
    v_cndmask_b32 v89, 0, v12, s[64:65]
    v_cndmask_b32 v90, 0, v12, s[66:67]
    v_cndmask_b32 v91, 0, v12, s[68:69]
    v_and_b32_dpp v13, v8, v11 row_newbcast:10 row_mask:0xf bank_mask:0x3
    s_nop 1
    v_and_b32_dpp v13, v8, v11 row_newbcast:11 row_mask:0xf bank_mask:0xc
    v_cndmask_b32 v92, 0, v13, s[62:63]
    v_cndmask_b32 v93, 0, v13, s[64:65]
    v_cndmask_b32 v94, 0, v13, s[66:67]
    v_cndmask_b32 v95, 0, v13, s[68:69]
    v_and_b32_dpp v12, v8, v11 row_newbcast:4 row_mask:0xf bank_mask:0x3
    s_nop 1
    v_and_b32_dpp v12, v8, v11 row_newbcast:5 row_mask:0xf bank_mask:0xc
    v_cndmask_b32 v96, 0, v12, s[62:63]
    v_cndmask_b32 v97, 0, v12, s[64:65]
    v_cndmask_b32 v98, 0, v12, s[66:67]
    v_cndmask_b32 v99, 0, v12, s[68:69]
    v_and_b32_dpp v13, v8, v11 row_newbcast:12 row_mask:0xf bank_mask:0x3
    s_nop 1
    v_and_b32_dpp v13, v8, v11 row_newbcast:13 row_mask:0xf bank_mask:0xc
    v_cndmask_b32 v100, 0, v13, s[62:63]
    v_cndmask_b32 v101, 0, v13, s[64:65]
    v_cndmask_b32 v102, 0, v13, s[66:67]
    v_cndmask_b32 v103, 0, v13, s[68:69]
    v_and_b32_dpp v12, v8, v11 row_newbcast:6 row_mask:0xf bank_mask:0x3
    s_nop 1
    v_and_b32_dpp v12, v8, v11 row_newbcast:7 row_mask:0xf bank_mask:0xc
    v_cndmask_b32 v104, 0, v12, s[62:63]
    v_cndmask_b32 v105, 0, v12, s[64:65]
    v_cndmask_b32 v106, 0, v12, s[66:67]
    v_cndmask_b32 v107, 0, v12, s[68:69]
    v_and_b32_dpp v13, v8, v11 row_newbcast:14 row_mask:0xf bank_mask:0x3
    s_nop 1
    v_and_b32_dpp v13, v8, v11 row_newbcast:15 row_mask:0xf bank_mask:0xc
    v_cndmask_b32 v108, 0, v13, s[62:63]
    v_cndmask_b32 v109, 0, v13, s[64:65]
    v_cndmask_b32 v110, 0, v13, s[66:67]
    v_cndmask_b32 v111, 0, v13, s[68:69]
    s_waitcnt vmcnt(15)
    v_mfma_f32_16x16x32_bf16 v[124:127], v[80:83], v[16:19], 0
    v_and_b32_dpp v12, v9, v11 row_newbcast:0 row_mask:0xf bank_mask:0x3
    s_nop 1
    v_and_b32_dpp v12, v9, v11 row_newbcast:1 row_mask:0xf bank_mask:0xc
    v_cndmask_b32 v112, 0, v12, s[62:63]
    v_cndmask_b32 v113, 0, v12, s[64:65]
    v_cndmask_b32 v114, 0, v12, s[66:67]
    v_cndmask_b32 v115, 0, v12, s[68:69]
    s_waitcnt vmcnt(14)
    v_mfma_f32_16x16x32_bf16 v[124:127], v[84:87], v[20:23], v[124:127]
    v_and_b32_dpp v13, v9, v11 row_newbcast:8 row_mask:0xf bank_mask:0x3
    s_nop 1
    v_and_b32_dpp v13, v9, v11 row_newbcast:9 row_mask:0xf bank_mask:0xc
    v_cndmask_b32 v116, 0, v13, s[62:63]
    v_cndmask_b32 v117, 0, v13, s[64:65]
    v_cndmask_b32 v118, 0, v13, s[66:67]
    v_cndmask_b32 v119, 0, v13, s[68:69]
    s_waitcnt vmcnt(13)
    v_mfma_f32_16x16x32_bf16 v[124:127], v[88:91], v[24:27], v[124:127]
    v_and_b32_dpp v12, v9, v11 row_newbcast:2 row_mask:0xf bank_mask:0x3
    s_nop 1
    v_and_b32_dpp v12, v9, v11 row_newbcast:3 row_mask:0xf bank_mask:0xc
    v_cndmask_b32 v120, 0, v12, s[62:63]
    v_cndmask_b32 v121, 0, v12, s[64:65]
    v_cndmask_b32 v122, 0, v12, s[66:67]
    v_cndmask_b32 v123, 0, v12, s[68:69]
    s_waitcnt vmcnt(12)
    v_mfma_f32_16x16x32_bf16 v[124:127], v[92:95], v[28:31], v[124:127]
    v_and_b32_dpp v13, v9, v11 row_newbcast:10 row_mask:0xf bank_mask:0x3
    s_nop 1
    v_and_b32_dpp v13, v9, v11 row_newbcast:11 row_mask:0xf bank_mask:0xc
    v_cndmask_b32 v80, 0, v13, s[62:63]
    v_cndmask_b32 v81, 0, v13, s[64:65]
    v_cndmask_b32 v82, 0, v13, s[66:67]
    v_cndmask_b32 v83, 0, v13, s[68:69]
    s_waitcnt vmcnt(11)
    v_mfma_f32_16x16x32_bf16 v[124:127], v[96:99], v[32:35], v[124:127]
    v_and_b32_dpp v12, v9, v11 row_newbcast:4 row_mask:0xf bank_mask:0x3
    s_nop 1
    v_and_b32_dpp v12, v9, v11 row_newbcast:5 row_mask:0xf bank_mask:0xc
    v_cndmask_b32 v84, 0, v12, s[62:63]
    v_cndmask_b32 v85, 0, v12, s[64:65]
    v_cndmask_b32 v86, 0, v12, s[66:67]
    v_cndmask_b32 v87, 0, v12, s[68:69]
    s_waitcnt vmcnt(10)
    v_mfma_f32_16x16x32_bf16 v[124:127], v[100:103], v[36:39], v[124:127]
    v_and_b32_dpp v13, v9, v11 row_newbcast:12 row_mask:0xf bank_mask:0x3
    s_nop 1
    v_and_b32_dpp v13, v9, v11 row_newbcast:13 row_mask:0xf bank_mask:0xc
    v_cndmask_b32 v88, 0, v13, s[62:63]
    v_cndmask_b32 v89, 0, v13, s[64:65]
    v_cndmask_b32 v90, 0, v13, s[66:67]
    v_cndmask_b32 v91, 0, v13, s[68:69]
    s_waitcnt vmcnt(9)
    v_mfma_f32_16x16x32_bf16 v[124:127], v[104:107], v[40:43], v[124:127]
    v_and_b32_dpp v12, v9, v11 row_newbcast:6 row_mask:0xf bank_mask:0x3
    s_nop 1
    v_and_b32_dpp v12, v9, v11 row_newbcast:7 row_mask:0xf bank_mask:0xc
    v_cndmask_b32 v92, 0, v12, s[62:63]
    v_cndmask_b32 v93, 0, v12, s[64:65]
    v_cndmask_b32 v94, 0, v12, s[66:67]
    v_cndmask_b32 v95, 0, v12, s[68:69]
    s_waitcnt vmcnt(8)
    v_mfma_f32_16x16x32_bf16 v[124:127], v[108:111], v[44:47], v[124:127]
    v_and_b32_dpp v13, v9, v11 row_newbcast:14 row_mask:0xf bank_mask:0x3
    s_nop 1
    v_and_b32_dpp v13, v9, v11 row_newbcast:15 row_mask:0xf bank_mask:0xc
    v_cndmask_b32 v96, 0, v13, s[62:63]
    v_cndmask_b32 v97, 0, v13, s[64:65]
    v_cndmask_b32 v98, 0, v13, s[66:67]
    v_cndmask_b32 v99, 0, v13, s[68:69]
    s_waitcnt vmcnt(7)
    v_mfma_f32_16x16x32_bf16 v[124:127], v[112:115], v[48:51], v[124:127]
    s_waitcnt vmcnt(6)
    v_mfma_f32_16x16x32_bf16 v[124:127], v[116:119], v[52:55], v[124:127]
    s_waitcnt vmcnt(5)
    v_mfma_f32_16x16x32_bf16 v[124:127], v[120:123], v[56:59], v[124:127]
    s_waitcnt vmcnt(4)
    v_mfma_f32_16x16x32_bf16 v[124:127], v[80:83], v[60:63], v[124:127]
    s_waitcnt vmcnt(3)
    v_mfma_f32_16x16x32_bf16 v[124:127], v[84:87], v[64:67], v[124:127]
    s_waitcnt vmcnt(2)
    v_mfma_f32_16x16x32_bf16 v[124:127], v[88:91], v[68:71], v[124:127]
    s_waitcnt vmcnt(1)
    v_mfma_f32_16x16x32_bf16 v[124:127], v[92:95], v[72:75], v[124:127]
    s_waitcnt vmcnt(0)
    v_mfma_f32_16x16x32_bf16 v[124:127], v[96:99], v[76:79], v[124:127]
    s_nop 7
    ds_write2_b64 v4, v[124:125], v[126:127] offset0:0 offset1:2
    s_mov_b64 exec, 1
    ds_add_u32 v14, v15 offset:144
    s_endpgm
L_init:
    s_barrier
    v_lshrrev_b32 v60, 2, v0
    v_lshlrev_b32 v60, 7, v60
    v_and_b32 v61, 3, v0
    v_lshl_add_u32 v60, v61, 4, v60
    v_mov_b32 v120, 0
    v_mov_b32 v121, 0
    v_mov_b32 v122, 0
    v_mov_b32 v123, 0
    s_mul_i32 s62, s2, 6272
    s_add_u32 s62, s62, 0x240000
    s_add_u32 s63, s62, 4096
    s_waitcnt lgkmcnt(0)
    s_setprio 3
    s_mov_b64 s[36:37], s[34:35]
    s_load_dword s60, s[34:35], 0
    s_getreg_b32 s0, hwreg(HW_REG_XCC_ID)
    s_and_b32 s0, s0, 15
    s_add_u32 s0, s0, 1
    s_mul_i32 s0, s0, 0x01000193
    buffer_store_dwordx4 v[120:123], v60, s[36:39], s62 offen sc1
    buffer_store_dwordx4 v[120:123], v60, s[36:39], s62 offen offset:2048 sc1
    buffer_store_dwordx4 v[120:123], v60, s[36:39], s63 offen sc1
    s_waitcnt lgkmcnt(0)
    s_mul_i32 s60, s60, 1664525
    s_add_u32 s60, s60, 1013904223
    s_xor_b32 s81, s60, s0
    v_mov_b32 v61, s60
    s_lshl_b32 s7, s2, 2
    s_add_u32 s7, s7, 0x1000
    s_waitcnt vmcnt(0)
    s_mov_b64 exec, 1
    buffer_store_dword v61, v14, s[36:39], s7 offen sc1
    s_mov_b64 exec, -1
    s_branch L_V2
L_W0b:
    s_mov_b32 s50, 0x480
    s_mov_b32 s51, 0x20000
    s_mov_b64 s[48:49], s[28:29]
    v_mul_u32_u24 v47, 2560, v61
    v_add_u32 v47, v47, v44
    s_mul_i32 s70, s4, 10240
    s_add_u32 s70, s70, 0x2000
    s_add_u32 s71, s70, 5120
    v_lshrrev_b32 v45, 1, v45
    v_lshl_add_u32 v45, v61, 1, v45
    v_min_u32 v46, 16, v0
    v_lshlrev_b32 v46, 7, v46
    s_mul_i32 s56, s6, 2176
    s_add_u32 s56, s56, 0x40000
    s_mov_b32 s57, 0
    s_waitcnt vmcnt(0)
    buffer_load_dwordx4 v[64:67], v47, s[36:39], s70 offen offset:0 sc1
    buffer_load_dwordx4 v[68:71], v47, s[36:39], s71 offen offset:0 sc1
    buffer_load_dwordx4 v[72:75], v47, s[36:39], s70 offen offset:640 sc1
    buffer_load_dwordx4 v[76:79], v47, s[36:39], s71 offen offset:640 sc1
    buffer_load_dwordx4 v[80:83], v47, s[36:39], s70 offen offset:1280 sc1
    buffer_load_dwordx4 v[84:87], v47, s[36:39], s71 offen offset:1280 sc1
    buffer_load_dwordx4 v[88:91], v47, s[36:39], s70 offen offset:1920 sc1
    buffer_load_dwordx4 v[92:95], v47, s[36:39], s71 offen offset:1920 sc1
    buffer_load_dword v102, v46, s[36:39], s56 offen
    buffer_load_dwordx4 v[104:107], v60, s[40:43], 0 offen
    buffer_load_dwordx4 v[108:111], v60, s[40:43], 0 offen offset:1024
    buffer_load_dwordx4 v[120:123], v60, s[48:51], 0 offen
    buffer_load_dwordx4 v[124:127], v60, s[48:51], 0 offen offset:1024
    s_mov_b32 s80, 0
    s_mov_b32 s1, s81
    s_mov_b64 s[8:9], -1
    s_mov_b64 s[10:11], -1
    s_mov_b64 s[12:13], -1
    s_mov_b64 s[14:15], -1
    s_mov_b64 s[16:17], -1
    s_mov_b64 s[18:19], -1
    s_mov_b64 s[20:21], -1
    s_mov_b64 s[22:23], -1
    s_waitcnt vmcnt(5)
    s_branch L_gc_27
L_gp_25:
    s_add_u32 s80, s80, 1
    s_cmp_lt_u32 s80, 2
    s_cbranch_scc1 L_gf_28
    s_cmp_lg_u32 s80, 2
    s_cbranch_scc1 L_gt_29
    s_mov_b32 s57, 1
    s_mov_b64 exec, 1
    ds_add_u32 v100, v101 offset:28
    s_mov_b64 exec, -1
    v_mov_b32 v117, s60
    v_mov_b32 v119, s60
    s_add_u32 s72, s72, 0x400000
    s_mov_b32 exec_hi, 0
    buffer_store_dwordx4 v[116:119], v44, s[36:39], s72 offen sc1
    s_mov_b32 exec_hi, -1
L_gt_29:
    v_xor_b32 v47, 0x400000, v47
    s_xor_b32 s1, s1, s0
L_gf_28:
    s_mov_b64 exec, s[8:9]
    s_cbranch_execz L_gs_30
    buffer_load_dwordx4 v[64:67], v47, s[36:39], s70 offen offset:0 sc1
L_gs_30:
    s_mov_b64 exec, s[10:11]
    s_cbranch_execz L_gs_31
    buffer_load_dwordx4 v[68:71], v47, s[36:39], s71 offen offset:0 sc1
L_gs_31:
    s_mov_b64 exec, s[12:13]
    s_cbranch_execz L_gs_32
    buffer_load_dwordx4 v[72:75], v47, s[36:39], s70 offen offset:640 sc1
L_gs_32:
    s_mov_b64 exec, s[14:15]
    s_cbranch_execz L_gs_33
    buffer_load_dwordx4 v[76:79], v47, s[36:39], s71 offen offset:640 sc1
L_gs_33:
    s_mov_b64 exec, s[16:17]
    s_cbranch_execz L_gs_34
    buffer_load_dwordx4 v[80:83], v47, s[36:39], s70 offen offset:1280 sc1
L_gs_34:
    s_mov_b64 exec, s[18:19]
    s_cbranch_execz L_gs_35
    buffer_load_dwordx4 v[84:87], v47, s[36:39], s71 offen offset:1280 sc1
L_gs_35:
    s_mov_b64 exec, s[20:21]
    s_cbranch_execz L_gs_36
    buffer_load_dwordx4 v[88:91], v47, s[36:39], s70 offen offset:1920 sc1
L_gs_36:
    s_mov_b64 exec, s[22:23]
    s_cbranch_execz L_gs_37
    buffer_load_dwordx4 v[92:95], v47, s[36:39], s71 offen offset:1920 sc1
L_gs_37:
    s_mov_b64 exec, -1
    s_waitcnt vmcnt(0)
L_gc_27:
    v_cmp_ne_u32 s[74:75], s1, v65
    v_cmp_ne_u32 vcc, s1, v67
    s_or_b64 vcc, s[74:75], vcc
    s_and_b64 s[8:9], s[8:9], vcc
    v_cmp_ne_u32 s[74:75], s1, v69
    v_cmp_ne_u32 vcc, s1, v71
    s_or_b64 vcc, s[74:75], vcc
    s_and_b64 s[10:11], s[10:11], vcc
    s_or_b64 s[82:83], s[8:9], s[10:11]
    v_cmp_ne_u32 s[74:75], s1, v73
    v_cmp_ne_u32 vcc, s1, v75
    s_or_b64 vcc, s[74:75], vcc
    s_and_b64 s[12:13], s[12:13], vcc
    s_or_b64 s[82:83], s[82:83], s[12:13]
    v_cmp_ne_u32 s[74:75], s1, v77
    v_cmp_ne_u32 vcc, s1, v79
    s_or_b64 vcc, s[74:75], vcc
    s_and_b64 s[14:15], s[14:15], vcc
    s_or_b64 s[82:83], s[82:83], s[14:15]
    v_cmp_ne_u32 s[74:75], s1, v81
    v_cmp_ne_u32 vcc, s1, v83
    s_or_b64 vcc, s[74:75], vcc
    s_and_b64 s[16:17], s[16:17], vcc
    s_or_b64 s[82:83], s[82:83], s[16:17]
    v_cmp_ne_u32 s[74:75], s1, v85
    v_cmp_ne_u32 vcc, s1, v87
    s_or_b64 vcc, s[74:75], vcc
    s_and_b64 s[18:19], s[18:19], vcc
    s_or_b64 s[82:83], s[82:83], s[18:19]
    v_cmp_ne_u32 s[74:75], s1, v89
    v_cmp_ne_u32 vcc, s1, v91
    s_or_b64 vcc, s[74:75], vcc
    s_and_b64 s[20:21], s[20:21], vcc
    s_or_b64 s[82:83], s[82:83], s[20:21]
    v_cmp_ne_u32 s[74:75], s1, v93
    v_cmp_ne_u32 vcc, s1, v95
    s_or_b64 vcc, s[74:75], vcc
    s_and_b64 s[22:23], s[22:23], vcc
    s_or_b64 s[82:83], s[82:83], s[22:23]
    s_cbranch_scc0 L_gpd_26
    s_sleep 1
    s_sub_u32 s61, s61, 1
    s_cbranch_scc0 L_gp_25
    s_endpgm
L_gpd_26:
    v_add_f32 v64, v64, v68
    v_add_f32 v66, v66, v70
    v_add_f32 v72, v72, v76
    v_add_f32 v74, v74, v78
    v_add_f32 v80, v80, v84
    v_add_f32 v82, v82, v86
    v_add_f32 v88, v88, v92
    v_add_f32 v90, v90, v94
    v_permlane32_swap_b32 v64, v66
    v_permlane32_swap_b32 v72, v74
    v_permlane32_swap_b32 v80, v82
    v_permlane32_swap_b32 v88, v90
    v_add_f32 v64, v64, v66
    v_cvt_pk_bf16_f32 v64, v64, v64
    ds_write_b16 v45, v64 offset:512
    v_add_f32 v72, v72, v74
    v_cvt_pk_bf16_f32 v72, v72, v72
    ds_write_b16 v45, v72 offset:640
    v_add_f32 v80, v80, v82
    v_cvt_pk_bf16_f32 v80, v80, v80
    ds_write_b16 v45, v80 offset:768
    v_add_f32 v88, v88, v90
    v_cvt_pk_bf16_f32 v88, v88, v88
    ds_write_b16 v45, v88 offset:896
    s_mov_b64 exec, 1
    ds_add_u32 v100, v101 offset:4
    s_mov_b64 exec, -1
    s_setprio 0
    s_waitcnt vmcnt(0)
    v_mov_b32 v16, 0
    v_lshlrev_b32 v20, 16, v104
    v_and_b32 v21, 0xffff0000, v104
    v_lshlrev_b32 v22, 16, v120
    v_and_b32 v23, 0xffff0000, v120
    v_mul_f32 v20, v20, v22
    v_mul_f32 v21, v21, v23
    v_cvt_pk_bf16_f32 v20, v20, v21
    v_lshlrev_b32 v21, 16, v20
    v_and_b32 v20, 0xffff0000, v20
    v_add_f32 v16, v16, v21
    v_add_f32 v16, v16, v20
    v_lshlrev_b32 v20, 16, v105
    v_and_b32 v21, 0xffff0000, v105
    v_lshlrev_b32 v22, 16, v121
    v_and_b32 v23, 0xffff0000, v121
    v_mul_f32 v20, v20, v22
    v_mul_f32 v21, v21, v23
    v_cvt_pk_bf16_f32 v20, v20, v21
    v_lshlrev_b32 v21, 16, v20
    v_and_b32 v20, 0xffff0000, v20
    v_add_f32 v16, v16, v21
    v_add_f32 v16, v16, v20
    v_lshlrev_b32 v20, 16, v106
    v_and_b32 v21, 0xffff0000, v106
    v_lshlrev_b32 v22, 16, v122
    v_and_b32 v23, 0xffff0000, v122
    v_mul_f32 v20, v20, v22
    v_mul_f32 v21, v21, v23
    v_cvt_pk_bf16_f32 v20, v20, v21
    v_lshlrev_b32 v21, 16, v20
    v_and_b32 v20, 0xffff0000, v20
    v_add_f32 v16, v16, v21
    v_add_f32 v16, v16, v20
    v_lshlrev_b32 v20, 16, v107
    v_and_b32 v21, 0xffff0000, v107
    v_lshlrev_b32 v22, 16, v123
    v_and_b32 v23, 0xffff0000, v123
    v_mul_f32 v20, v20, v22
    v_mul_f32 v21, v21, v23
    v_cvt_pk_bf16_f32 v20, v20, v21
    v_lshlrev_b32 v21, 16, v20
    v_and_b32 v20, 0xffff0000, v20
    v_add_f32 v16, v16, v21
    v_add_f32 v16, v16, v20
    v_lshlrev_b32 v20, 16, v108
    v_and_b32 v21, 0xffff0000, v108
    v_lshlrev_b32 v22, 16, v124
    v_and_b32 v23, 0xffff0000, v124
    v_mul_f32 v20, v20, v22
    v_mul_f32 v21, v21, v23
    v_cvt_pk_bf16_f32 v20, v20, v21
    v_lshlrev_b32 v21, 16, v20
    v_and_b32 v20, 0xffff0000, v20
    v_add_f32 v16, v16, v21
    v_add_f32 v16, v16, v20
    v_lshlrev_b32 v20, 16, v109
    v_and_b32 v21, 0xffff0000, v109
    v_lshlrev_b32 v22, 16, v125
    v_and_b32 v23, 0xffff0000, v125
    v_mul_f32 v20, v20, v22
    v_mul_f32 v21, v21, v23
    v_cvt_pk_bf16_f32 v20, v20, v21
    v_lshlrev_b32 v21, 16, v20
    v_and_b32 v20, 0xffff0000, v20
    v_add_f32 v16, v16, v21
    v_add_f32 v16, v16, v20
    v_lshlrev_b32 v20, 16, v110
    v_and_b32 v21, 0xffff0000, v110
    v_lshlrev_b32 v22, 16, v126
    v_and_b32 v23, 0xffff0000, v126
    v_mul_f32 v20, v20, v22
    v_mul_f32 v21, v21, v23
    v_cvt_pk_bf16_f32 v20, v20, v21
    v_lshlrev_b32 v21, 16, v20
    v_and_b32 v20, 0xffff0000, v20
    v_add_f32 v16, v16, v21
    v_add_f32 v16, v16, v20
    v_lshlrev_b32 v20, 16, v111
    v_and_b32 v21, 0xffff0000, v111
    v_lshlrev_b32 v22, 16, v127
    v_and_b32 v23, 0xffff0000, v127
    v_mul_f32 v20, v20, v22
    v_mul_f32 v21, v21, v23
    v_cvt_pk_bf16_f32 v20, v20, v21
    v_lshlrev_b32 v21, 16, v20
    v_and_b32 v20, 0xffff0000, v20
    v_add_f32 v16, v16, v21
    v_add_f32 v16, v16, v20
    s_nop 1
    v_add_f32_dpp v16, v16, v16 quad_perm:[1,0,3,2] row_mask:0xf bank_mask:0xf
    s_nop 1
    v_add_f32_dpp v16, v16, v16 quad_perm:[2,3,0,1] row_mask:0xf bank_mask:0xf
    s_nop 1
    v_add_f32_dpp v16, v16, v16 row_ror:4 row_mask:0xf bank_mask:0xf
    s_nop 1
    v_add_f32_dpp v16, v16, v16 row_ror:8 row_mask:0xf bank_mask:0xf
    v_mov_b32 v17, v16
    s_nop 1
    v_permlane16_swap_b32 v16, v17
    v_add_f32 v16, v16, v17
    v_mov_b32 v17, v16
    s_nop 1
    v_permlane32_swap_b32 v16, v17
    v_add_f32 v16, v16, v17
    v_cvt_pk_bf16_f32 v16, v16, v16
    v_and_b32 v16, 0xffff0000, v16
    v_mul_f32 v16, 0xbfb8aa3b, v16
    v_exp_f32 v16, v16
    s_nop 0
    v_add_f32 v16, 1.0, v16
    v_rcp_f32 v16, v16
    s_nop 0
    v_cvt_pk_bf16_f32 v16, v16, v16
    v_and_b32 v16, 0xffff0000, v16
    v_sub_f32 v17, 1.0, v16
    v_cvt_pk_bf16_f32 v17, v17, v17
    v_and_b32 v17, 0xffff0000, v17
    s_mov_b64 exec, 1
    ds_write_b64 v100, v[16:17] offset:40
    ds_add_u32 v100, v101 offset:16
    s_mov_b64 exec, -1
    s_setprio 3
    v_lshlrev_b32 v45, 2, v61
    v_and_b32 v47, 3, v0
    v_lshlrev_b32 v47, 4, v47
    v_lshl_add_u32 v47, v61, 6, v47
    v_mov_b32 v25, s81
    v_mov_b32 v27, s81
    v_mov_b32 v81, s81
    v_mov_b32 v83, s81
    v_mov_b32 v85, s81
    v_mov_b32 v87, s81
    v_and_b32 v44, 15, v0
    v_lshl_add_u32 v44, v61, 4, v44
    v_lshlrev_b32 v44, 2, v44
L_lw_38:
    ds_read_b32 v20, v100 offset:8
    s_waitcnt lgkmcnt(0)
    v_readfirstlane_b32 s7, v20
    s_cmp_ge_u32 s7, 8
    s_cbranch_scc1 L_lwd_39
    s_sleep 2
    s_sub_u32 s61, s61, 1
    s_cbranch_scc0 L_lw_38
    s_endpgm
L_lwd_39:
    ds_read_b32 v26, v44 offset:256
    ds_read_b32 v24, v45 offset:32
    s_waitcnt lgkmcnt(0)
    v_add_f32_dpp v26, v26, v26 quad_perm:[1,0,3,2] row_mask:0xf bank_mask:0xf
    s_nop 1
    v_add_f32_dpp v26, v26, v26 quad_perm:[2,3,0,1] row_mask:0xf bank_mask:0xf
    s_nop 1
    v_add_f32_dpp v26, v26, v26 row_ror:4 row_mask:0xf bank_mask:0xf
    s_nop 1
    v_add_f32_dpp v26, v26, v26 row_ror:8 row_mask:0xf bank_mask:0xf
    v_mul_f32 v24, 0x3fb8aa3b, v24
    s_mov_b32 exec_lo, 0xf
    s_mov_b32 exec_hi, 0xf
    buffer_store_dwordx4 v[24:27], v47, s[36:39], s56 offen offset:2048
    s_mov_b64 exec, -1
L_lw_40:
    ds_read_b32 v20, v100 offset:144
    s_waitcnt lgkmcnt(0)
    v_readfirstlane_b32 s7, v20
    s_cmp_ge_u32 s7, 3
    s_cbranch_scc1 L_lwd_41
    s_sleep 1
    s_sub_u32 s61, s61, 1
    s_cbranch_scc0 L_lw_40
    s_endpgm
L_lwd_41:
L_ow_42:
    ds_read_b32 v20, v100 offset:144
    ds_read_b128 v[28:31], v60 offset:4096
    ds_read_b128 v[32:35], v60 offset:5120
    ds_read_b128 v[36:39], v60 offset:6144
    ds_read_b128 v[40:43], v60 offset:7168
    s_waitcnt lgkmcnt(4)
    v_readfirstlane_b32 s7, v20
    s_cmp_ge_u32 s7, 4
    s_cbranch_scc1 L_owd_43
    s_waitcnt lgkmcnt(0)
    s_sub_u32 s61, s61, 1
    s_cbranch_scc0 L_ow_42
    s_endpgm
L_owd_43:
    s_waitcnt lgkmcnt(2)
    v_add_f32 v28, v28, v32
    v_add_f32 v29, v29, v33
    v_add_f32 v30, v30, v34
    v_add_f32 v31, v31, v35
    s_waitcnt lgkmcnt(0)
    v_add_f32 v36, v36, v40
    v_add_f32 v37, v37, v41
    v_add_f32 v38, v38, v42
    v_add_f32 v39, v39, v43
    v_add_f32 v80, v28, v36
    v_add_f32 v82, v29, v37
    v_add_f32 v84, v30, v38
    v_add_f32 v86, v31, v39
    buffer_store_dwordx4 v[80:83], v60, s[36:39], s56 offen
    buffer_store_dwordx4 v[84:87], v60, s[36:39], s56 offen offset:1024
    s_mov_b64 exec, 1
    ds_add_u32 v100, v101 offset:12
    s_mov_b64 exec, -1
    s_cmp_eq_u32 s57, 0
    s_cbranch_scc1 L_W0_end
    v_mov_b32 v25, s60
    v_mov_b32 v27, s60
    v_mov_b32 v81, s60
    v_mov_b32 v83, s60
    v_mov_b32 v85, s60
    v_mov_b32 v87, s60
    s_add_u32 s56, s56, 0x400000
    buffer_store_dwordx4 v[80:83], v60, s[36:39], s56 offen sc1
    buffer_store_dwordx4 v[84:87], v60, s[36:39], s56 offen offset:1024 sc1
    s_mov_b32 exec_lo, 0xf
    s_mov_b32 exec_hi, 0xf
    buffer_store_dwordx4 v[24:27], v47, s[36:39], s56 offen offset:2048 sc1
L_W0_end:
    s_endpgm
L_K:
    v_mov_b32 v80, 0
    v_mov_b32 v81, 0
    v_mov_b32 v82, 0
    v_mov_b32 v83, 0
    v_mov_b32 v84, 0
    v_mov_b32 v85, 0
    v_mov_b32 v86, 0
    v_mov_b32 v87, 0
    v_and_b32 v3, 3, v0
    v_lshlrev_b32 v3, 4, v3
    v_bfe_u32 v4, v0, 3, 1
    v_lshl_add_u32 v3, v4, 6, v3
    v_bfe_u32 v4, v0, 4, 1
    v_lshl_add_u32 v3, v4, 8, v3
    s_mov_b32 s74, 0xaaaaaaaa
    s_mov_b32 s75, 0xaaaaaaaa
    s_mov_b32 s76, 0xcccccccc
    s_mov_b32 s77, 0xcccccccc
    s_mov_b32 s78, 0xf0f0f0f0
    s_mov_b32 s79, 0xf0f0f0f0
    v_and_b32 v13, 1, v0
    v_lshlrev_b32 v12, 2, v13
    s_lshl_b32 s7, s72, 9
    v_lshl_add_u32 v2, v0, 3, s7
    s_lshl_b32 s7, s72, 2
    v_mov_b32 v11, s7
    v_lshrrev_b32 v1, 4, v0
    v_lshl_add_u32 v1, v13, 4, v1
    s_lshl_b32 s7, s72, 2
    v_add_u32 v1, s7, v1
    v_lshlrev_b32 v1, 2, v1
    s_mov_b32 exec_lo, 0xf0f0f0f
    s_mov_b32 exec_hi, 0xf0f0f0f0
L_qw_44:
    ds_read_b32 v10, v14 offset:4
    ds_read_b128 v[80:83], v3 offset:512
    ds_read_b128 v[84:87], v3 offset:640
    s_waitcnt lgkmcnt(0)
    v_readfirstlane_b32 s7, v10
    s_cmp_lg_u32 s7, 0
    s_cbranch_scc1 L_qwd_45
    s_sub_u32 s61, s61, 1
    s_cbranch_scc0 L_qw_44
    s_endpgm
L_qwd_45:
    s_mov_b64 exec, -1
    s_waitcnt vmcnt(15)
    v_mfma_f32_32x32x16_bf16 v[96:111], v[80:83], v[16:19], 0
    s_waitcnt vmcnt(14)
    v_mfma_f32_32x32x16_bf16 v[96:111], v[84:87], v[20:23], v[96:111]
    s_waitcnt vmcnt(13)
    v_mfma_f32_32x32x16_bf16 v[112:127], v[80:83], v[24:27], 0
    s_waitcnt vmcnt(12)
    v_mfma_f32_32x32x16_bf16 v[112:127], v[84:87], v[28:31], v[112:127]
    s_nop 7
    v_cndmask_b32 v96, v96, v105, s[74:75]
    v_cndmask_b32 v104, v104, v97, s[74:75]
    v_cndmask_b32 v98, v98, v107, s[74:75]
    v_cndmask_b32 v106, v106, v99, s[74:75]
    v_cndmask_b32 v100, v100, v109, s[74:75]
    v_cndmask_b32 v108, v108, v101, s[74:75]
    v_cndmask_b32 v102, v102, v111, s[74:75]
    v_cndmask_b32 v110, v110, v103, s[74:75]
    v_cndmask_b32 v104, v104, v106, s[76:77]
    v_cndmask_b32 v108, v108, v110, s[76:77]
    v_cndmask_b32 v96, v96, v98, s[76:77]
    v_cndmask_b32 v100, v100, v102, s[76:77]
    v_cndmask_b32 v4, v104, v108, s[78:79]
    v_cndmask_b32 v3, v96, v100, s[78:79]
    s_nop 1
    v_add_f32_dpp v5, v4, v3 quad_perm:[1,0,3,2] row_mask:0xf bank_mask:0xf
    s_waitcnt vmcnt(11)
    v_mfma_f32_32x32x16_bf16 v[96:111], v[80:83], v[32:35], 0
    v_cndmask_b32 v112, v112, v121, s[74:75]
    v_cndmask_b32 v120, v120, v113, s[74:75]
    v_cndmask_b32 v114, v114, v123, s[74:75]
    v_cndmask_b32 v122, v122, v115, s[74:75]
    v_cndmask_b32 v116, v116, v125, s[74:75]
    s_waitcnt vmcnt(10)
    v_mfma_f32_32x32x16_bf16 v[96:111], v[84:87], v[36:39], v[96:111]
    v_cndmask_b32 v124, v124, v117, s[74:75]
    v_cndmask_b32 v118, v118, v127, s[74:75]
    v_cndmask_b32 v126, v126, v119, s[74:75]
    v_cndmask_b32 v120, v120, v122, s[76:77]
    v_cndmask_b32 v124, v124, v126, s[76:77]
    v_cndmask_b32 v112, v112, v114, s[76:77]
    v_cndmask_b32 v116, v116, v118, s[76:77]
    v_cndmask_b32 v4, v120, v124, s[78:79]
    v_cndmask_b32 v3, v112, v116, s[78:79]
    s_nop 1
    v_add_f32_dpp v6, v4, v3 quad_perm:[1,0,3,2] row_mask:0xf bank_mask:0xf
    v_cndmask_b32 v4, v6, v5, s[76:77]
    v_cndmask_b32 v3, v5, v6, s[76:77]
    s_nop 1
    v_add_f32_dpp v7, v4, v3 quad_perm:[2,3,0,1] row_mask:0xf bank_mask:0xf
    s_waitcnt vmcnt(9)
    v_mfma_f32_32x32x16_bf16 v[112:127], v[80:83], v[40:43], 0
    v_cndmask_b32 v96, v96, v105, s[74:75]
    v_cndmask_b32 v104, v104, v97, s[74:75]
    v_cndmask_b32 v98, v98, v107, s[74:75]
    v_cndmask_b32 v106, v106, v99, s[74:75]
    v_cndmask_b32 v100, v100, v109, s[74:75]
    s_waitcnt vmcnt(8)
    v_mfma_f32_32x32x16_bf16 v[112:127], v[84:87], v[44:47], v[112:127]
    v_cndmask_b32 v108, v108, v101, s[74:75]
    v_cndmask_b32 v102, v102, v111, s[74:75]
    v_cndmask_b32 v110, v110, v103, s[74:75]
    v_cndmask_b32 v104, v104, v106, s[76:77]
    v_cndmask_b32 v108, v108, v110, s[76:77]
    v_cndmask_b32 v96, v96, v98, s[76:77]
    v_cndmask_b32 v100, v100, v102, s[76:77]
    v_cndmask_b32 v4, v104, v108, s[78:79]
    v_cndmask_b32 v3, v96, v100, s[78:79]
    s_nop 1
    v_add_f32_dpp v5, v4, v3 quad_perm:[1,0,3,2] row_mask:0xf bank_mask:0xf
    s_waitcnt vmcnt(7)
    v_mfma_f32_32x32x16_bf16 v[96:111], v[80:83], v[48:51], 0
    v_cndmask_b32 v112, v112, v121, s[74:75]
    v_cndmask_b32 v120, v120, v113, s[74:75]
    v_cndmask_b32 v114, v114, v123, s[74:75]
    v_cndmask_b32 v122, v122, v115, s[74:75]
    v_cndmask_b32 v116, v116, v125, s[74:75]
    s_waitcnt vmcnt(6)
    v_mfma_f32_32x32x16_bf16 v[96:111], v[84:87], v[52:55], v[96:111]
    v_cndmask_b32 v124, v124, v117, s[74:75]
    v_cndmask_b32 v118, v118, v127, s[74:75]
    v_cndmask_b32 v126, v126, v119, s[74:75]
    v_cndmask_b32 v120, v120, v122, s[76:77]
    v_cndmask_b32 v124, v124, v126, s[76:77]
    v_cndmask_b32 v112, v112, v114, s[76:77]
    v_cndmask_b32 v116, v116, v118, s[76:77]
    v_cndmask_b32 v4, v120, v124, s[78:79]
    v_cndmask_b32 v3, v112, v116, s[78:79]
    s_nop 1
    v_add_f32_dpp v6, v4, v3 quad_perm:[1,0,3,2] row_mask:0xf bank_mask:0xf
    v_cndmask_b32 v4, v6, v5, s[76:77]
    v_cndmask_b32 v3, v5, v6, s[76:77]
    s_nop 1
    v_add_f32_dpp v10, v4, v3 quad_perm:[2,3,0,1] row_mask:0xf bank_mask:0xf
    v_add_f32_dpp v5, v7, v7 row_ror:12 row_mask:0xf bank_mask:0x5
    s_nop 1
    v_add_f32_dpp v5, v10, v10 row_ror:4 row_mask:0xf bank_mask:0xa
    v_cvt_pk_bf16_f32 v5, v5, v5
    v_and_b32 v5, 0xffff0000, v5
    v_mul_f32 v5, 0x3db504f3, v5
    v_cvt_pk_bf16_f32 v5, v5, v5
    v_and_b32 v8, 0xffff0000, v5
    s_waitcnt vmcnt(5)
    v_mfma_f32_32x32x16_bf16 v[112:127], v[80:83], v[56:59], 0
    v_cndmask_b32 v96, v96, v105, s[74:75]
    v_cndmask_b32 v104, v104, v97, s[74:75]
    v_cndmask_b32 v98, v98, v107, s[74:75]
    v_cndmask_b32 v106, v106, v99, s[74:75]
    v_cndmask_b32 v100, v100, v109, s[74:75]
    s_waitcnt vmcnt(4)
    v_mfma_f32_32x32x16_bf16 v[112:127], v[84:87], v[60:63], v[112:127]
    v_cndmask_b32 v108, v108, v101, s[74:75]
    v_cndmask_b32 v102, v102, v111, s[74:75]
    v_cndmask_b32 v110, v110, v103, s[74:75]
    v_cndmask_b32 v104, v104, v106, s[76:77]
    v_cndmask_b32 v108, v108, v110, s[76:77]
    v_cndmask_b32 v96, v96, v98, s[76:77]
    v_cndmask_b32 v100, v100, v102, s[76:77]
    v_cndmask_b32 v4, v104, v108, s[78:79]
    v_cndmask_b32 v3, v96, v100, s[78:79]
    s_nop 1
    v_add_f32_dpp v5, v4, v3 quad_perm:[1,0,3,2] row_mask:0xf bank_mask:0xf
    s_waitcnt vmcnt(3)
    v_mfma_f32_32x32x16_bf16 v[96:111], v[80:83], v[64:67], 0
    v_cndmask_b32 v112, v112, v121, s[74:75]
    v_cndmask_b32 v120, v120, v113, s[74:75]
    v_cndmask_b32 v114, v114, v123, s[74:75]
    v_cndmask_b32 v122, v122, v115, s[74:75]
    v_cndmask_b32 v116, v116, v125, s[74:75]
    s_waitcnt vmcnt(2)
    v_mfma_f32_32x32x16_bf16 v[96:111], v[84:87], v[68:71], v[96:111]
    v_cndmask_b32 v124, v124, v117, s[74:75]
    v_cndmask_b32 v118, v118, v127, s[74:75]
    v_cndmask_b32 v126, v126, v119, s[74:75]
    v_cndmask_b32 v120, v120, v122, s[76:77]
    v_cndmask_b32 v124, v124, v126, s[76:77]
    v_cndmask_b32 v112, v112, v114, s[76:77]
    v_cndmask_b32 v116, v116, v118, s[76:77]
    v_cndmask_b32 v4, v120, v124, s[78:79]
    v_cndmask_b32 v3, v112, v116, s[78:79]
    s_nop 1
    v_add_f32_dpp v6, v4, v3 quad_perm:[1,0,3,2] row_mask:0xf bank_mask:0xf
    v_cndmask_b32 v4, v6, v5, s[76:77]
    v_cndmask_b32 v3, v5, v6, s[76:77]
    s_nop 1
    v_add_f32_dpp v7, v4, v3 quad_perm:[2,3,0,1] row_mask:0xf bank_mask:0xf
    s_waitcnt vmcnt(1)
    v_mfma_f32_32x32x16_bf16 v[112:127], v[80:83], v[72:75], 0
    v_cndmask_b32 v96, v96, v105, s[74:75]
    v_cndmask_b32 v104, v104, v97, s[74:75]
    v_cndmask_b32 v98, v98, v107, s[74:75]
    v_cndmask_b32 v106, v106, v99, s[74:75]
    v_cndmask_b32 v100, v100, v109, s[74:75]
    s_waitcnt vmcnt(0)
    v_mfma_f32_32x32x16_bf16 v[112:127], v[84:87], v[76:79], v[112:127]
    v_cndmask_b32 v108, v108, v101, s[74:75]
    v_cndmask_b32 v102, v102, v111, s[74:75]
    v_cndmask_b32 v110, v110, v103, s[74:75]
    v_cndmask_b32 v104, v104, v106, s[76:77]
    v_cndmask_b32 v108, v108, v110, s[76:77]
    v_cndmask_b32 v96, v96, v98, s[76:77]
    v_cndmask_b32 v100, v100, v102, s[76:77]
    v_cndmask_b32 v4, v104, v108, s[78:79]
    v_cndmask_b32 v3, v96, v100, s[78:79]
    s_nop 1
    v_add_f32_dpp v5, v4, v3 quad_perm:[1,0,3,2] row_mask:0xf bank_mask:0xf
    v_cndmask_b32 v112, v112, v121, s[74:75]
    v_cndmask_b32 v120, v120, v113, s[74:75]
    v_cndmask_b32 v114, v114, v123, s[74:75]
    v_cndmask_b32 v122, v122, v115, s[74:75]
    v_cndmask_b32 v116, v116, v125, s[74:75]
    v_cndmask_b32 v124, v124, v117, s[74:75]
    v_cndmask_b32 v118, v118, v127, s[74:75]
    v_cndmask_b32 v126, v126, v119, s[74:75]
    v_cndmask_b32 v120, v120, v122, s[76:77]
    v_cndmask_b32 v124, v124, v126, s[76:77]
    v_cndmask_b32 v112, v112, v114, s[76:77]
    v_cndmask_b32 v116, v116, v118, s[76:77]
    v_cndmask_b32 v4, v120, v124, s[78:79]
    v_cndmask_b32 v3, v112, v116, s[78:79]
    s_nop 1
    v_add_f32_dpp v6, v4, v3 quad_perm:[1,0,3,2] row_mask:0xf bank_mask:0xf
    v_cndmask_b32 v4, v6, v5, s[76:77]
    v_cndmask_b32 v3, v5, v6, s[76:77]
    s_nop 1
    v_add_f32_dpp v10, v4, v3 quad_perm:[2,3,0,1] row_mask:0xf bank_mask:0xf
    v_add_f32_dpp v5, v7, v7 row_ror:12 row_mask:0xf bank_mask:0x5
    s_nop 1
    v_add_f32_dpp v5, v10, v10 row_ror:4 row_mask:0xf bank_mask:0xa
    v_cvt_pk_bf16_f32 v5, v5, v5
    v_and_b32 v5, 0xffff0000, v5
    v_mul_f32 v5, 0x3db504f3, v5
    v_cvt_pk_bf16_f32 v5, v5, v5
    v_and_b32 v9, 0xffff0000, v5
    v_max_f32 v5, v8, v9
    s_nop 1
    v_max_f32_dpp v5, v5, v5 quad_perm:[2,3,0,1] row_mask:0xf bank_mask:0xf
    s_nop 1
    v_max_f32_dpp v5, v5, v5 row_ror:4 row_mask:0xf bank_mask:0xf
    s_nop 1
    v_max_f32_dpp v5, v5, v5 row_ror:8 row_mask:0xf bank_mask:0xf
    s_mov_b32 exec_lo, 0x30003
    s_mov_b32 exec_hi, 0x30003
    ds_max_f32 v12, v5 offset:32
    s_mov_b64 exec, 1
    ds_add_u32 v14, v15 offset:8
    s_mov_b64 exec, -1
L_mw_46:
    ds_read_b32 v10, v14 offset:8
    ds_read_b32 v5, v12 offset:32
    s_waitcnt lgkmcnt(0)
    v_readfirstlane_b32 s7, v10
    s_cmp_ge_u32 s7, 4
    s_cbranch_scc1 L_mwd_47
    s_sub_u32 s61, s61, 1
    s_cbranch_scc0 L_mw_46
    s_endpgm
L_mwd_47:
    v_sub_f32 v8, v8, v5
    v_mul_f32 v8, 0x3fb8aa3b, v8
    v_exp_f32 v8, v8
    v_sub_f32 v9, v9, v5
    v_mul_f32 v9, 0x3fb8aa3b, v9
    v_exp_f32 v9, v9
    s_nop 0
    v_add_f32 v5, v8, v9
    v_cvt_pk_bf16_f32 v8, v8, v8
    v_cvt_pk_bf16_f32 v9, v9, v9
    ds_write_b64 v2, v[8:9] offset:8192
    ds_write_b32 v11, v15 offset:128
    v_add_f32_dpp v5, v5, v5 quad_perm:[2,3,0,1] row_mask:0xf bank_mask:0xf
    s_nop 1
    v_add_f32_dpp v5, v5, v5 row_ror:4 row_mask:0xf bank_mask:0xf
    s_nop 1
    v_add_f32_dpp v5, v5, v5 row_ror:8 row_mask:0xf bank_mask:0xf
    s_mov_b32 exec_lo, 0x30003
    s_mov_b32 exec_hi, 0x30003
    ds_write_b32 v1, v5 offset:256
    s_mov_b64 exec, 1
    ds_add_u32 v14, v15 offset:8
    s_endpgm
L_D:
    s_sub_u32 s79, s3, 12
    s_and_b32 s72, s5, 3
    s_and_b32 s5, s5, 12
    s_add_u32 s5, s5, s79
    s_lshl_b32 s6, s4, 4
    s_or_b32 s6, s6, s5
    s_and_b32 s7, s4, 1
    s_lshl_b32 s78, s5, 1
    s_or_b32 s78, s78, s7
    s_cmp_eq_u32 s72, 3
    s_cbranch_scc1 L_end
    v_lshrrev_b32 v15, 4, v0
    v_bfe_u32 v4, v0, 3, 1
    v_lshl_add_u32 v15, v15, 2, v4
    v_mul_u32_u24 v15, 1152, v15
    v_add_u32 v15, v15, v2
    s_mul_i32 s7, s72, 384
    s_mul_i32 s70, s6, 18432
    s_add_u32 s70, s70, s7
    s_and_b32 s74, s78, 3
    s_bfe_u32 s75, s78, 0x10002
    s_mul_i32 s75, s75, 9
    s_lshl_b32 s7, s74, 1
    s_add_u32 s75, s75, s7
    s_mul_i32 s73, s77, 576
    s_lshl_b32 s7, s74, 7
    s_add_u32 s73, s73, s7
    s_lshl_b32 s7, s75, 3
    s_add_u32 s73, s73, s7
    s_bfe_u32 s7, s78, 0x10003
    s_lshl_b32 s7, s7, 2
    s_add_u32 s73, s73, s7
    s_bfe_u32 s7, s78, 0x10004
    s_lshl_b32 s7, s7, 1
    s_add_u32 s73, s73, s7
    s_lshr_b32 s76, s78, 3
    s_mul_i32 s76, s76, 384
    s_lshl_b32 s7, s75, 4
    s_add_u32 s76, s76, s7
    s_mul_i32 s73, s73, 1152
    s_mul_i32 s7, s72, 384
    s_add_u32 s73, s73, s7
    v_lshrrev_b32 v4, 1, v1
    v_and_b32 v5, 1, v1
    v_lshl_add_u32 v4, v4, 3, v5
    v_mul_u32_u24 v4, 1152, v4
    v_add_u32 v125, v4, v2
    v_add_u32 v126, 36864, v125
    v_add_u32 v127, 73728, v125
    v_lshlrev_b32 v122, 1, v1
    v_add_u32 v124, 32, v122
    v_min_u32 v124, 34, v124
    s_and_b32 s7, s79, 1
    s_lshl_b32 s7, s7, 7
    s_lshr_b32 s74, s79, 1
    s_mul_i32 s74, s74, 36
    s_add_u32 s7, s7, s74
    v_add_u32 v122, s7, v122
    v_add_u32 v123, 16, v122
    v_add_u32 v124, s7, v124
    v_mov_b32 v9, 0x40000000
    v_cmp_gt_u32 vcc, 16, v0
    s_nop 1
    v_cndmask_b32 v127, v9, v127, vcc
    s_mov_b32 s42, 0x480000
    s_mov_b32 s43, 0x20000
    s_mov_b32 s46, 0x510000
    s_mov_b32 s47, 0x20000
    s_mov_b32 s50, 0x480
    s_mov_b32 s51, 0x20000
    s_mov_b32 s54, 0x480
    s_mov_b32 s55, 0x20000
    v_bfe_u32 v5, v0, 4, 1
    v_lshl_add_u32 v10, v5, 3, v2
    v_lshrrev_b32 v5, 5, v0
    v_lshl_add_u32 v10, v5, 2, v10
    v_bfe_u32 v5, v0, 3, 1
    v_lshl_add_u32 v10, v5, 1, v10
    s_mul_i32 s7, s72, 384
    v_add_u32 v10, s7, v10
    v_mov_b32 v92, 0
    v_mov_b32 v93, 0
    v_mov_b32 v94, 0
    v_mov_b32 v4, 0
    s_waitcnt lgkmcnt(0)
    s_mov_b64 s[40:41], s[16:17]
    s_mov_b64 s[44:45], s[24:25]
    s_mov_b64 s[48:49], s[26:27]
    s_mov_b64 s[52:53], s[30:31]
    s_mov_b64 s[36:37], s[34:35]
    s_load_dword s60, s[34:35], 0
    s_getreg_b32 s0, hwreg(HW_REG_XCC_ID)
    s_and_b32 s0, s0, 15
    s_add_u32 s0, s0, 1
    s_mul_i32 s0, s0, 0x01000193
    s_cmp_lg_u32 s6, 0
    s_cbranch_scc1 L_nob2
    buffer_load_ushort v92, v10, s[48:51], 0 offen offset:0
    buffer_load_ushort v93, v10, s[48:51], 0 offen offset:128
    buffer_load_ushort v94, v10, s[48:51], 0 offen offset:256
L_nob2:
    s_mov_b32 s62, 0x3030303
    s_mov_b32 s63, 0x3030303
    s_mov_b32 s64, 0xc0c0c0c
    s_mov_b32 s65, 0xc0c0c0c
    s_mov_b32 s66, 0x30303030
    s_mov_b32 s67, 0x30303030
    s_mov_b32 s68, 0xc0c0c0c0
    s_mov_b32 s69, 0xc0c0c0c0
    v_lshrrev_b32 v12, 4, v0
    v_lshlrev_b32 v12, 7, v12
    v_and_b32 v5, 15, v0
    v_lshl_add_u32 v12, v5, 2, v12
    s_lshl_b32 s71, s72, 11
    s_add_u32 s71, s71, 0x240000
    v_mov_b32 v95, 0
    s_movk_i32 s20, 0x1000
    v_add_u32 v5, 128, v10
    v_add_u32 v6, 256, v10
    v_mov_b32 v14, v10
    s_nop 1
    v_mov_b32_dpp v14, v10 row_ror:4 row_mask:0xf bank_mask:0x1
    s_nop 1
    v_mov_b32_dpp v14, v5 row_ror:8 row_mask:0xf bank_mask:0x2
    s_nop 1
    v_mov_b32_dpp v14, v6 row_ror:12 row_mask:0xf bank_mask:0x4
    v_and_b32 v5, 15, v0
    v_cmp_gt_u32 vcc, 13, v5
    s_nop 1
    v_cndmask_b32 v12, v9, v12, vcc
    v_cmp_gt_u32 vcc, 12, v5
    s_nop 1
    v_cndmask_b32 v10, v9, v10, vcc
    v_cndmask_b32 v14, v9, v14, vcc
    v_lshrrev_b32 v13, 4, v0
    v_mul_u32_u24 v7, 2176, v13
    v_lshl_add_u32 v7, v5, 3, v7
    v_lshl_add_u32 v6, v5, 2, v13
    v_mul_u32_u24 v6, 2176, v6
    v_cmp_gt_u32 vcc, 4, v5
    s_nop 1
    v_cndmask_b32 v6, v9, v6, vcc
    v_mov_b32 v3, 1.0
    s_mul_i32 s56, s4, 34816
    s_add_u32 s56, s56, 0x40000
    s_lshr_b32 s7, s5, 3
    s_lshl_b32 s7, s7, 6
    s_add_u32 s19, s56, s7
    s_lshl_b32 s7, s5, 7
    s_add_u32 s56, s56, s7
    s_add_u32 s57, s56, 8704
    s_add_u32 s58, s56, 17408
    s_add_u32 s59, s56, 26112
    v_and_b32 v5, 1, v0
    v_cmp_eq_u32 vcc, 1, v5
    v_mov_b32 v120, 0x0c0c0100
    v_mov_b32 v5, 0x01000c0c
    v_cndmask_b32 v120, v120, v5, vcc
    v_mov_b32 v121, 0x0c0c0302
    v_mov_b32 v5, 0x03020c0c
    v_cndmask_b32 v121, v121, v5, vcc
    v_and_b32 v5, 8, v0
    v_cmp_ne_u32 vcc, 0, v5
    s_nop 1
    v_cndmask_b32 v121, v120, v121, vcc
    s_mov_b32 s78, 0x10001000
    s_mov_b32 s79, 0x10001000
    s_mov_b32 s21, 0x427c0000
    s_waitcnt lgkmcnt(0)
    s_mul_i32 s60, s60, 1664525
    s_add_u32 s60, s60, 1013904223
    s_xor_b32 s81, s60, s0
L_lw_48:
    ds_read_b32 v5, v4 offset:24
    s_waitcnt lgkmcnt(0)
    v_readfirstlane_b32 s7, v5
    s_cmp_ge_u32 s7, 4
    s_cbranch_scc1 L_lwd_49
    s_sleep 1
    s_sub_u32 s61, s61, 1
    s_cbranch_scc0 L_lw_48
    s_endpgm
L_lwd_49:
    buffer_load_dwordx4 v[40:43], v125, s[44:47], s73 offen offset:0 nt
    buffer_load_dwordx4 v[44:47], v126, s[44:47], s73 offen offset:0 nt
    buffer_load_dwordx4 v[48:51], v127, s[44:47], s73 offen offset:0 nt
    s_nop 0
    buffer_load_dwordx4 v[52:55], v125, s[44:47], s73 offen offset:128 nt
    buffer_load_dwordx4 v[56:59], v126, s[44:47], s73 offen offset:128 nt
    buffer_load_dwordx4 v[60:63], v127, s[44:47], s73 offen offset:128 nt
    s_nop 0
    buffer_load_dwordx4 v[64:67], v125, s[44:47], s73 offen offset:256 nt
    buffer_load_dwordx4 v[68:71], v126, s[44:47], s73 offen offset:256 nt
    buffer_load_dwordx4 v[72:75], v127, s[44:47], s73 offen offset:256 nt
    s_nop 0
    buffer_load_dwordx4 v[84:87], v6, s[36:39], s19 offen offset:2048 sc1
    buffer_load_dword v11, v95, s[36:39], s20 offen sc1
L_lw_50:
    ds_read_b32 v5, v4 offset:16
    s_waitcnt lgkmcnt(0)
    v_readfirstlane_b32 s7, v5
    s_cmp_ge_u32 s7, 3
    s_cbranch_scc1 L_lwd_51
    s_sleep 1
    s_sub_u32 s61, s61, 1
    s_cbranch_scc0 L_lw_50
    s_endpgm
L_lwd_51:
    ds_read_u16 v108, v122 offset:2048
    ds_read_u16 v109, v123 offset:2048
    ds_read_u16 v110, v124 offset:2048
    ds_read_b64 v[8:9], v4 offset:40
    s_waitcnt lgkmcnt(0)
    v_perm_b32 v112, v108, v108, v120
    v_cndmask_b32 v96, 0, v112, s[62:63]
    v_cndmask_b32 v97, 0, v112, s[64:65]
    v_cndmask_b32 v98, 0, v112, s[66:67]
    v_cndmask_b32 v99, 0, v112, s[68:69]
    v_perm_b32 v113, v109, v109, v120
    v_cndmask_b32 v100, 0, v113, s[62:63]
    v_cndmask_b32 v101, 0, v113, s[64:65]
    v_cndmask_b32 v102, 0, v113, s[66:67]
    v_cndmask_b32 v103, 0, v113, s[68:69]
    v_perm_b32 v114, v110, v110, v120
    v_cndmask_b32 v104, 0, v114, s[62:63]
    v_cndmask_b32 v105, 0, v114, s[64:65]
    v_cndmask_b32 v106, 0, v114, s[66:67]
    v_cndmask_b32 v107, 0, v114, s[68:69]
L_lw_52:
    ds_read_b32 v5, v4 offset:12
    s_waitcnt lgkmcnt(0)
    v_readfirstlane_b32 s7, v5
    s_cmp_ge_u32 s7, 1
    s_cbranch_scc1 L_lwd_53
    s_sub_u32 s61, s61, 1
    s_cbranch_scc0 L_lw_52
    s_endpgm
L_lwd_53:
    buffer_load_dwordx4 v[16:19], v15, s[40:43], s70 offen offset:0 nt
    buffer_load_dwordx4 v[20:23], v15, s[40:43], s70 offen offset:2304 nt
    buffer_load_dwordx4 v[24:27], v15, s[40:43], s70 offen offset:128 nt
    s_nop 0
    buffer_load_dwordx4 v[28:31], v15, s[40:43], s70 offen offset:2432 nt
    buffer_load_dwordx4 v[32:35], v15, s[40:43], s70 offen offset:256 nt
    buffer_load_dwordx4 v[36:39], v15, s[40:43], s70 offen offset:2560 nt
    s_waitcnt vmcnt(14)
    v_mfma_f32_16x16x32_bf16 v[108:111], v[96:99], v[40:43], 0
    v_mfma_f32_16x16x32_bf16 v[108:111], v[100:103], v[44:47], v[108:111]
    v_mfma_f32_16x16x32_bf16 v[108:111], v[104:107], v[48:51], v[108:111]
    s_waitcnt vmcnt(11)
    v_mfma_f32_16x16x32_bf16 v[112:115], v[96:99], v[52:55], 0
    v_mfma_f32_16x16x32_bf16 v[112:115], v[100:103], v[56:59], v[112:115]
    v_mfma_f32_16x16x32_bf16 v[112:115], v[104:107], v[60:63], v[112:115]
    s_waitcnt vmcnt(8)
    v_mfma_f32_16x16x32_bf16 v[116:119], v[96:99], v[64:67], 0
    v_mfma_f32_16x16x32_bf16 v[116:119], v[100:103], v[68:71], v[116:119]
    v_mfma_f32_16x16x32_bf16 v[116:119], v[104:107], v[72:75], v[116:119]
    v_permlane32_swap_b32 v108, v110
    v_permlane32_swap_b32 v109, v111
    s_nop 1
    v_permlane32_swap_b32 v112, v114
    v_permlane32_swap_b32 v113, v115
    s_nop 1
    v_permlane32_swap_b32 v116, v118
    v_permlane32_swap_b32 v117, v119
    v_add_f32_dpp v40, v110, v108 row_ror:8 row_mask:0xf bank_mask:0x3
    s_nop 1
    v_add_f32_dpp v40, v109, v111 row_ror:8 row_mask:0xf bank_mask:0xc
    v_add_f32_dpp v41, v114, v112 row_ror:8 row_mask:0xf bank_mask:0x3
    s_nop 1
    v_add_f32_dpp v41, v113, v115 row_ror:8 row_mask:0xf bank_mask:0xc
    v_add_f32_dpp v42, v118, v116 row_ror:8 row_mask:0xf bank_mask:0x3
    s_nop 1
    v_add_f32_dpp v42, v117, v119 row_ror:8 row_mask:0xf bank_mask:0xc
    v_lshlrev_b32 v92, 16, v92
    v_add_f32 v40, v40, v92
    v_mul_f32 v40, v9, v40
    v_lshlrev_b32 v93, 16, v93
    v_add_f32 v41, v41, v93
    v_mul_f32 v41, v9, v41
    v_lshlrev_b32 v94, 16, v94
    v_add_f32 v42, v42, v94
    v_mul_f32 v42, v9, v42
    v_lshlrev_b32 v68, 4, v0
    s_sub_u32 s7, s3, 12
    s_lshl_b32 s7, s7, 10
    v_add_u32 v69, s7, v68
    v_mov_b32 v70, 1
    v_mov_b32 v5, 0x0c0c0c0c
    v_cndmask_b32 v72, v5, v121, s[62:63]
    v_cndmask_b32 v73, v5, v121, s[64:65]
    v_cndmask_b32 v74, v5, v121, s[66:67]
    v_cndmask_b32 v75, v5, v121, s[68:69]
    ds_read_b32 v5, v4 offset:28
    s_waitcnt lgkmcnt(0)
    v_readfirstlane_b32 s7, v5
    s_mul_i32 s7, s7, 4096
    s_mov_b32 s80, s7
    s_mov_b32 s1, s81
    s_mov_b64 s[8:9], -1
    s_mov_b64 s[10:11], -1
    s_mov_b64 s[12:13], -1
    s_mov_b64 s[14:15], -1
    s_mov_b32 s24, 0xf000f
    s_mov_b32 s25, 0xf000f
    s_waitcnt vmcnt(6)
    s_branch L_igc_56
L_ig_54:
    buffer_load_dword v11, v95, s[36:39], s20 offen sc1
    s_waitcnt vmcnt(0)
L_igc_56:
    v_cmp_ne_u32 vcc, s60, v11
    s_cmp_eq_u64 vcc, 0
    s_cbranch_scc1 L_igd_55
    s_sleep 2
    s_sub_u32 s61, s61, 1
    s_cbranch_scc0 L_ig_54
    s_endpgm
L_igd_55:
    v_cmp_ne_u32 s[74:75], s1, v85
    v_cmp_ne_u32 vcc, s1, v87
    s_or_b64 vcc, s[74:75], vcc
    s_and_b64 s[24:25], s[24:25], vcc
    s_mov_b64 s[22:23], s[24:25]
    s_cbranch_scc1 L_ml1
    v_max_f32_dpp v52, v84, v84 quad_perm:[1,0,3,2] row_mask:0xf bank_mask:0xf
    s_nop 1
    v_max_f32_dpp v52, v52, v52 quad_perm:[2,3,0,1] row_mask:0xf bank_mask:0xf
    v_mov_b32 v53, v52
    s_nop 1
    v_permlane16_swap_b32 v52, v53
    v_max_f32 v52, v52, v53
    v_mov_b32 v53, v52
    s_nop 1
    v_permlane32_swap_b32 v52, v53
    v_max_f32 v52, v52, v53
    v_sub_f32 v52, v84, v52
    v_exp_f32 v52, v52
    s_nop 0
    v_mul_f32 v54, v52, v86
    s_nop 1
    v_add_f32_dpp v54, v54, v54 quad_perm:[1,0,3,2] row_mask:0xf bank_mask:0xf
    s_nop 1
    v_add_f32_dpp v54, v54, v54 quad_perm:[2,3,0,1] row_mask:0xf bank_mask:0xf
    v_mov_b32 v53, v54
    s_nop 1
    v_permlane16_swap_b32 v54, v53
    v_add_f32 v54, v54, v53
    v_mov_b32 v53, v54
    s_nop 1
    v_permlane32_swap_b32 v54, v53
    v_add_f32 v54, v54, v53
    v_rcp_f32 v54, v54
    s_nop 0
    v_mul_f32 v52, v52, v54
    s_nop 1
    v_mov_b32_dpp v88, v52 row_newbcast:0 row_mask:0xf bank_mask:0xf
    v_mov_b32_dpp v89, v52 row_newbcast:1 row_mask:0xf bank_mask:0xf
    v_mov_b32_dpp v90, v52 row_newbcast:2 row_mask:0xf bank_mask:0xf
    v_mov_b32_dpp v91, v52 row_newbcast:3 row_mask:0xf bank_mask:0xf
L_ml1:
L_lw_57:
    ds_read_b32 v5, v4 offset:12
    s_waitcnt lgkmcnt(0)
    v_readfirstlane_b32 s7, v5
    s_cmp_ge_u32 s7, 1
    s_cbranch_scc1 L_lwd_58
    s_sub_u32 s61, s61, 1
    s_cbranch_scc0 L_lw_57
    s_endpgm
L_lwd_58:
    s_cmp_lg_u64 s[22:23], 0
    s_cbranch_scc1 L_og
    s_cmp_ge_u32 s80, 4095
    s_cbranch_scc1 L_og
L_ot:
    buffer_load_dwordx2 v[76:77], v7, s[36:39], s56 offen offset:0 sc1
    buffer_load_dwordx2 v[78:79], v7, s[36:39], s57 offen offset:0 sc1
    buffer_load_dwordx2 v[80:81], v7, s[36:39], s58 offen offset:0 sc1
    buffer_load_dwordx2 v[82:83], v7, s[36:39], s59 offen offset:0 sc1
    s_add_u32 s80, s80, 1
    s_waitcnt vmcnt(3)
    v_mul_f32 v52, v88, v76
    s_waitcnt vmcnt(2)
    v_fmac_f32 v52, v89, v78
    s_waitcnt vmcnt(1)
    v_fmac_f32 v52, v90, v80
    s_waitcnt vmcnt(0)
    v_fmac_f32 v52, v91, v82
    s_nop 1
    v_mfma_f32_16x16x4_f32 v[64:67], v52, v3, 0
    v_cmp_ne_u32 s[8:9], s81, v77
    v_cmp_ne_u32 s[10:11], s81, v79
    v_cmp_ne_u32 s[12:13], s81, v81
    v_cmp_ne_u32 s[14:15], s81, v83
    s_or_b64 s[74:75], s[8:9], s[10:11]
    s_or_b64 s[82:83], s[12:13], s[14:15]
    s_or_b64 s[74:75], s[74:75], s[82:83]
    s_cbranch_scc0 L_od
    s_cmp_lt_u32 s80, 4095
    s_cbranch_scc1 L_ot
L_og:
    s_branch L_gf_62
L_gp_59:
    s_add_u32 s80, s80, 1
    s_cmp_lt_u32 s80, 4096
    s_cbranch_scc1 L_gf_62
    v_xor_b32 v6, 0x400000, v6
    v_xor_b32 v7, 0x400000, v7
    s_xor_b32 s1, s1, s0
L_gf_62:
    s_mov_b64 exec, s[24:25]
    s_cbranch_execz L_gs_63
    buffer_load_dwordx4 v[84:87], v6, s[36:39], s19 offen offset:2048 sc1
L_gs_63:
    s_mov_b64 exec, s[8:9]
    s_cbranch_execz L_gs_64
    buffer_load_dwordx2 v[76:77], v7, s[36:39], s56 offen offset:0 sc1
L_gs_64:
    s_mov_b64 exec, s[10:11]
    s_cbranch_execz L_gs_65
    buffer_load_dwordx2 v[78:79], v7, s[36:39], s57 offen offset:0 sc1
L_gs_65:
    s_mov_b64 exec, s[12:13]
    s_cbranch_execz L_gs_66
    buffer_load_dwordx2 v[80:81], v7, s[36:39], s58 offen offset:0 sc1
L_gs_66:
    s_mov_b64 exec, s[14:15]
    s_cbranch_execz L_gs_67
    buffer_load_dwordx2 v[82:83], v7, s[36:39], s59 offen offset:0 sc1
L_gs_67:
    s_mov_b64 exec, -1
    s_waitcnt vmcnt(0)
L_gc_61:
    v_cmp_ne_u32 s[74:75], s1, v85
    v_cmp_ne_u32 vcc, s1, v87
    s_or_b64 vcc, s[74:75], vcc
    s_and_b64 s[24:25], s[24:25], vcc
    v_xor_b32 v53, s1, v77
    s_nop 1
    v_or_b32_dpp v53, v53, v53 quad_perm:[1,0,3,2] row_mask:0xf bank_mask:0xf
    v_cmp_ne_u32 vcc, 0, v53
    s_and_b64 s[8:9], s[8:9], vcc
    s_or_b64 s[82:83], s[24:25], s[8:9]
    v_xor_b32 v53, s1, v79
    s_nop 1
    v_or_b32_dpp v53, v53, v53 quad_perm:[1,0,3,2] row_mask:0xf bank_mask:0xf
    v_cmp_ne_u32 vcc, 0, v53
    s_and_b64 s[10:11], s[10:11], vcc
    s_or_b64 s[82:83], s[82:83], s[10:11]
    v_xor_b32 v53, s1, v81
    s_nop 1
    v_or_b32_dpp v53, v53, v53 quad_perm:[1,0,3,2] row_mask:0xf bank_mask:0xf
    v_cmp_ne_u32 vcc, 0, v53
    s_and_b64 s[12:13], s[12:13], vcc
    s_or_b64 s[82:83], s[82:83], s[12:13]
    v_xor_b32 v53, s1, v83
    s_nop 1
    v_or_b32_dpp v53, v53, v53 quad_perm:[1,0,3,2] row_mask:0xf bank_mask:0xf
    v_cmp_ne_u32 vcc, 0, v53
    s_and_b64 s[14:15], s[14:15], vcc
    s_or_b64 s[82:83], s[82:83], s[14:15]
    s_cbranch_scc0 L_gpd_60
    s_cmp_eq_u64 s[22:23], 0
    s_cbranch_scc1 L_ml3
    s_or_b64 s[22:23], s[24:25], s[24:25]
    s_cbranch_scc1 L_ml4
    v_max_f32_dpp v52, v84, v84 quad_perm:[1,0,3,2] row_mask:0xf bank_mask:0xf
    s_nop 1
    v_max_f32_dpp v52, v52, v52 quad_perm:[2,3,0,1] row_mask:0xf bank_mask:0xf
    v_mov_b32 v53, v52
    s_nop 1
    v_permlane16_swap_b32 v52, v53
    v_max_f32 v52, v52, v53
    v_mov_b32 v53, v52
    s_nop 1
    v_permlane32_swap_b32 v52, v53
    v_max_f32 v52, v52, v53
    v_sub_f32 v52, v84, v52
    v_exp_f32 v52, v52
    s_nop 0
    v_mul_f32 v54, v52, v86
    s_nop 1
    v_add_f32_dpp v54, v54, v54 quad_perm:[1,0,3,2] row_mask:0xf bank_mask:0xf
    s_nop 1
    v_add_f32_dpp v54, v54, v54 quad_perm:[2,3,0,1] row_mask:0xf bank_mask:0xf
    v_mov_b32 v53, v54
    s_nop 1
    v_permlane16_swap_b32 v54, v53
    v_add_f32 v54, v54, v53
    v_mov_b32 v53, v54
    s_nop 1
    v_permlane32_swap_b32 v54, v53
    v_add_f32 v54, v54, v53
    v_rcp_f32 v54, v54
    s_nop 0
    v_mul_f32 v52, v52, v54
    s_nop 1
    v_mov_b32_dpp v88, v52 row_newbcast:0 row_mask:0xf bank_mask:0xf
    v_mov_b32_dpp v89, v52 row_newbcast:1 row_mask:0xf bank_mask:0xf
    v_mov_b32_dpp v90, v52 row_newbcast:2 row_mask:0xf bank_mask:0xf
    v_mov_b32_dpp v91, v52 row_newbcast:3 row_mask:0xf bank_mask:0xf
L_ml3:
    s_cmp_lt_u32 s80, 4095
    s_cbranch_scc1 L_ot
L_ml4:
    s_sub_u32 s61, s61, 1
    s_cbranch_scc0 L_gp_59
    s_endpgm
L_gpd_60:
    s_cmp_eq_u64 s[22:23], 0
    s_cbranch_scc1 L_ml2
    v_max_f32_dpp v52, v84, v84 quad_perm:[1,0,3,2] row_mask:0xf bank_mask:0xf
    s_nop 1
    v_max_f32_dpp v52, v52, v52 quad_perm:[2,3,0,1] row_mask:0xf bank_mask:0xf
    v_mov_b32 v53, v52
    s_nop 1
    v_permlane16_swap_b32 v52, v53
    v_max_f32 v52, v52, v53
    v_mov_b32 v53, v52
    s_nop 1
    v_permlane32_swap_b32 v52, v53
    v_max_f32 v52, v52, v53
    v_sub_f32 v52, v84, v52
    v_exp_f32 v52, v52
    s_nop 0
    v_mul_f32 v54, v52, v86
    s_nop 1
    v_add_f32_dpp v54, v54, v54 quad_perm:[1,0,3,2] row_mask:0xf bank_mask:0xf
    s_nop 1
    v_add_f32_dpp v54, v54, v54 quad_perm:[2,3,0,1] row_mask:0xf bank_mask:0xf
    v_mov_b32 v53, v54
    s_nop 1
    v_permlane16_swap_b32 v54, v53
    v_add_f32 v54, v54, v53
    v_mov_b32 v53, v54
    s_nop 1
    v_permlane32_swap_b32 v54, v53
    v_add_f32 v54, v54, v53
    v_rcp_f32 v54, v54
    s_nop 0
    v_mul_f32 v52, v52, v54
    s_nop 1
    v_mov_b32_dpp v88, v52 row_newbcast:0 row_mask:0xf bank_mask:0xf
    v_mov_b32_dpp v89, v52 row_newbcast:1 row_mask:0xf bank_mask:0xf
    v_mov_b32_dpp v90, v52 row_newbcast:2 row_mask:0xf bank_mask:0xf
    v_mov_b32_dpp v91, v52 row_newbcast:3 row_mask:0xf bank_mask:0xf
L_ml2:
    v_mul_f32 v52, v88, v76
    v_fmac_f32 v52, v89, v78
    v_fmac_f32 v52, v90, v80
    v_fmac_f32 v52, v91, v82
    s_nop 1
    v_mfma_f32_16x16x4_f32 v[64:67], v52, v3, 0
    s_nop 7
L_od:
    s_nop 1
    v_cvt_pk_bf16_f32 v53, v64, v65
    v_cvt_pk_bf16_f32 v54, v66, v67
    v_perm_b32 v56, v53, v53, v72
    v_perm_b32 v57, v53, v53, v73
    v_perm_b32 v58, v53, v53, v74
    v_perm_b32 v59, v53, v53, v75
    v_perm_b32 v60, v54, v54, v72
    v_perm_b32 v61, v54, v54, v73
    v_mfma_f32_16x16x32_bf16 v[96:99], v[56:59], v[16:19], 0
    v_perm_b32 v62, v54, v54, v74
    v_perm_b32 v63, v54, v54, v75
    v_mfma_f32_16x16x32_bf16 v[100:103], v[56:59], v[24:27], 0
    v_mfma_f32_16x16x32_bf16 v[104:107], v[56:59], v[32:35], 0
    v_mfma_f32_16x16x32_bf16 v[96:99], v[60:63], v[20:23], v[96:99]
    v_mfma_f32_16x16x32_bf16 v[100:103], v[60:63], v[28:31], v[100:103]
    v_mfma_f32_16x16x32_bf16 v[104:107], v[60:63], v[36:39], v[104:107]
    s_nop 5
    v_permlane32_swap_b32 v96, v98
    v_permlane32_swap_b32 v97, v99
    v_permlane32_swap_b32 v100, v102
    v_permlane32_swap_b32 v101, v103
    v_permlane32_swap_b32 v104, v106
    v_permlane32_swap_b32 v105, v107
    v_add_f32_dpp v64, v98, v96 row_ror:8 row_mask:0xf bank_mask:0x3
    v_add_f32_dpp v65, v102, v100 row_ror:8 row_mask:0xf bank_mask:0x3
    v_add_f32_dpp v66, v106, v104 row_ror:8 row_mask:0xf bank_mask:0x3
    v_add_f32_dpp v64, v97, v99 row_ror:8 row_mask:0xf bank_mask:0xc
    v_add_f32_dpp v65, v101, v103 row_ror:8 row_mask:0xf bank_mask:0xc
    v_add_f32_dpp v66, v105, v107 row_ror:8 row_mask:0xf bank_mask:0xc
    v_fmac_f32 v40, v8, v64
    v_fmac_f32 v41, v8, v65
    v_fmac_f32 v42, v8, v66
    ds_write_b128 v69, v[40:43] offset:10240
    s_mov_b64 exec, 1
    ds_add_rtn_u32 v5, v4, v70 offset:60
    s_mov_b64 exec, -1
    ds_read_b128 v[96:99], v68 offset:10240
    ds_read_b128 v[100:103], v68 offset:11264
    ds_read_b128 v[104:107], v68 offset:12288
    ds_read_b128 v[108:111], v68 offset:13312
    s_waitcnt lgkmcnt(4)
    v_readfirstlane_b32 s7, v5
    s_cmp_lg_u32 s7, 3
    s_cbranch_scc1 L_D_end
    s_waitcnt lgkmcnt(2)
    v_add_f32 v40, v96, v100
    v_add_f32 v41, v97, v101
    v_add_f32 v42, v98, v102
    s_waitcnt lgkmcnt(0)
    v_add_f32 v104, v104, v108
    v_add_f32 v105, v105, v109
    v_add_f32 v106, v106, v110
    v_add_f32 v40, v40, v104
    v_add_f32 v41, v41, v105
    v_add_f32 v42, v42, v106
L_add:
    v_cndmask_b32 v44, v40, 1.0, s[78:79]
    buffer_atomic_add_f32 v44, v12, s[36:39], s71 offen offset:0 sc0
    v_mov_b32_dpp v43, v40 row_ror:4 row_mask:0xf bank_mask:0x1
    v_cndmask_b32 v45, v41, 1.0, s[78:79]
    buffer_atomic_add_f32 v45, v12, s[36:39], s71 offen offset:512 sc0
    v_mov_b32_dpp v43, v41 row_ror:8 row_mask:0xf bank_mask:0x2
    v_cndmask_b32 v46, v42, 1.0, s[78:79]
    buffer_atomic_add_f32 v46, v12, s[36:39], s71 offen offset:1024 sc0
    v_mov_b32_dpp v43, v42 row_ror:12 row_mask:0xf bank_mask:0x4
    v_cndmask_b32 v47, v43, 1.0, s[78:79]
    buffer_atomic_add_f32 v47, v12, s[36:39], s71 offen offset:1536 sc0
    v_mov_b32 v9, 0x40000000
    v_mov_b32 v5, s60
    s_waitcnt vmcnt(3)
    v_mov_b32_dpp v48, v44 row_newbcast:12 row_mask:0xf bank_mask:0xf
    v_cmp_eq_u32 s[24:25], s21, v48
    v_add_f32 v40, v40, v44
    v_cvt_pk_bf16_f32 v40, v40, v40
    v_cndmask_b32 v52, v9, v10, s[24:25]
    s_waitcnt vmcnt(2)
    v_mov_b32_dpp v49, v45 row_newbcast:12 row_mask:0xf bank_mask:0xf
    v_cmp_eq_u32 s[26:27], s21, v49
    v_add_f32 v41, v41, v45
    v_cvt_pk_bf16_f32 v41, v41, v41
    v_cndmask_b32 v53, v9, v10, s[26:27]
    s_waitcnt vmcnt(1)
    v_mov_b32_dpp v50, v46 row_newbcast:12 row_mask:0xf bank_mask:0xf
    v_cmp_eq_u32 s[28:29], s21, v50
    v_add_f32 v42, v42, v46
    v_cvt_pk_bf16_f32 v42, v42, v42
    v_cndmask_b32 v54, v9, v10, s[28:29]
    s_waitcnt vmcnt(0)
    buffer_store_short v40, v52, s[52:55], 0 offen offset:0
    buffer_store_short v41, v53, s[52:55], 0 offen offset:128
    buffer_store_short v42, v54, s[52:55], 0 offen offset:256
    v_mov_b32_dpp v51, v47 row_newbcast:12 row_mask:0xf bank_mask:0xf
    v_cmp_eq_u32 s[30:31], s21, v51
    v_add_f32 v43, v43, v47
    v_cvt_pk_bf16_f32 v43, v43, v43
    v_cndmask_b32 v55, v9, v14, s[30:31]
    buffer_store_short v43, v55, s[52:55], 0 offen offset:0
    s_bitcmp1_b32 s24, 0
    s_cbranch_scc0 L_D_end
    s_cmp_lg_u32 s72, 0
    s_cbranch_scc1 L_D_end
    s_mov_b64 exec, 1
    buffer_store_dword v5, v4, s[36:39], 0 offen
L_D_end:
L_end:
    s_endpgm
.section .rodata,"a"
.p2align 6
.amdhsa_kernel gated_mix__sliding_block_cached__dense_activation_gelu__decode_kernel
  .amdhsa_next_free_vgpr 128
  .amdhsa_next_free_sgpr 102
  .amdhsa_accum_offset 128
  .amdhsa_group_segment_fixed_size 0
  .amdhsa_kernarg_size 112
  .amdhsa_user_sgpr_count 2
  .amdhsa_user_sgpr_kernarg_segment_ptr 1
  .amdhsa_system_sgpr_workgroup_id_x 1
  .amdhsa_float_denorm_mode_32 3
.end_amdhsa_kernel
```
